```python
import torch

def _softmax(x, axis=-1):
    return torch.softmax(x, dim=axis)
def _gelu(x):
    return torch.nn.functional.gelu(x, approximate="tanh")
def _silu(x):
    return torch.nn.functional.silu(x)
def _sigmoid(x):
    return torch.sigmoid(x)
def _layernorm(x, axis=-1, eps=1e-5):
    m = x.mean(dim=axis, keepdim=True)
    v = x.var(dim=axis, keepdim=True, unbiased=False)
    return (x - m) / torch.sqrt(v + eps)
def _scatter_add(tgt, idx, src, axis=0):
    return tgt.clone().index_add_(axis, idx, src)
def _segment_sum(src, seg, n):
    out = torch.zeros((n,) + src.shape[1:], dtype=src.dtype)
    return out.index_add_(0, seg, src)
def _pad(x, pw):
    flat = tuple(v for pair in reversed(pw) for v in pair)
    return torch.nn.functional.pad(x, flat)

kernel_name = 'concat_heads__ssm_conv_h3__linear_kernel_hedgehog__prompt'

def setup_inputs():

    _w = (lambda a: (lambda t: t.to(torch.bfloat16) if t.is_floating_point() else t)(torch.as_tensor(a)))
    def _A_setup():
        B, S, D = 1, 2048, 1024
        ks = 4
        return {
            "q": _w((lambda *s: torch.randn(*s, dtype=torch.bfloat16) * 0.05)(B, S, D)),
            "k": _w((lambda *s: torch.randn(*s, dtype=torch.bfloat16) * 0.8)(B, S, D)),
            "v": _w((lambda *s: torch.randn(*s, dtype=torch.bfloat16) * 0.8)(B, S, D)),
            "shift_k": _w((lambda *s: torch.randn(*s, dtype=torch.bfloat16) * 0.8)(D, ks) * 0.5),
            "ssm_k": _w((lambda *s: torch.randn(*s, dtype=torch.bfloat16) * 0.8)(D, S) * (1.0 / S ** 0.5)),
            "ssm_D": _w((lambda *s: torch.randn(*s, dtype=torch.bfloat16) * 0.8)(D)),
        }
    _A_in = _A_setup()

    def _B_setup():
        B, S, D, H = 1, 2048, 1024, 32
        Dh = D // H
        return {
            "x": _w((lambda *s: torch.randn(*s, dtype=torch.bfloat16) * 0.4)(B, S, D)),
            "wqkv": _w((lambda *s: torch.randn(*s, dtype=torch.bfloat16) * 0.4)(D, 3 * D)),
            "w_phi": _w((lambda *s: torch.randn(*s, dtype=torch.bfloat16) * 0.4)(H, Dh, Dh) * (Dh ** -0.5)),
            "wo": _w((lambda *s: torch.randn(*s, dtype=torch.bfloat16) * 0.05)(D, D)),
        }
    _B_in = _B_setup()

    return {
        "A_q": _A_in["q"],
        "A_k": _A_in["k"],
        "A_v": _A_in["v"],
        "A_shift_k": _A_in["shift_k"],
        "A_ssm_k": _A_in["ssm_k"],
        "A_ssm_D": _A_in["ssm_D"],
        "B_x": _B_in["x"],
        "B_wqkv": _B_in["wqkv"],
        "B_w_phi": _B_in["w_phi"],
        "B_wo": _B_in["wo"],
    }

def reference(A_q, A_k, A_v, A_shift_k, A_ssm_k, A_ssm_D, B_x, B_wqkv, B_w_phi, B_wo):
    def _A_ref(q, k, v, shift_k, ssm_k, ssm_D):
        B, S, D = q.shape
        ks = shift_k.shape[-1]
        k_pad = _pad(k, ((0, 0), (ks - 1, 0), (0, 0)))
        k_shift = torch.zeros_like(k)
        for t in range(ks):
            k_shift = k_shift + k_pad[:, t:t + S, :] * shift_k[:, ks - 1 - t][None, None, :]
        kv = k_shift * v
        L = 2 * S
        kv_pad = _pad(kv, ((0, 0), (0, S), (0, 0)))
        kf_pad = _pad(ssm_k, ((0, 0), (0, S)))
        kv_f = (lambda x, axes=(-2,-1): torch.fft.rfft2(x.float(), dim=axes))(kv_pad[:, None, :, :], axes=(1, 2))
        kf_f = (lambda x, axes=(-2,-1): torch.fft.rfft2(x.float(), dim=axes))(kf_pad[:, None, :], axes=(1, 2))
        kf_f = (lambda x, *d: x.permute(*d))(kf_f, 1, 2, 0)
        y_f = kv_f * kf_f[None, :, :, :]
        y = (lambda x, s, axes=(-2,-1): torch.fft.irfft2(x, s=s, dim=axes).to(torch.bfloat16))(y_f, (1, L), axes=(1, 2))[:, 0, :S, :]
        y = y + kv * ssm_D[None, None, :]
        return q * y

    def _B_ref(x, wqkv, w_phi, wo):
        B, S, D = x.shape
        H = 32; Dh = D // H
        qkv = (lambda x, *d: x.permute(*d))((x @ wqkv).reshape(B, S, 3, H, Dh), 2, 0, 3, 1, 4)
        q, k, v = qkv[0], qkv[1], qkv[2]
        pq = torch.einsum("bhsd,hdf->bhsf", q, w_phi)
        pk = torch.einsum("bhsd,hdf->bhsf", k, w_phi)
        phi_q = torch.concatenate([_softmax(pq, axis=-1), _softmax(-pq, axis=-1)], axis=-1)
        phi_k = torch.concatenate([_softmax(pk, axis=-1), _softmax(-pk, axis=-1)], axis=-1)
        kv = torch.einsum("bhsf,bhsd->bhfd", phi_k, v)
        z  = torch.einsum("bhsf->bhf", phi_k)
        num = torch.einsum("bhqf,bhfd->bhqd", phi_q, kv)
        den = torch.einsum("bhqf,bhf->bhq", phi_q, z)[..., None] + 1e-6
        o = num / den
        return (lambda x, *d: x.permute(*d))(o, 0, 2, 1, 3).reshape(B, S, D) @ wo

    a = _A_ref(A_q, A_k, A_v, A_shift_k, A_ssm_k, A_ssm_D)
    b = _B_ref(B_x, B_wqkv, B_w_phi, B_wo)
    return torch.concatenate([a, b], axis=-1)
```

```asm
; @launch grid=(256,1,1) block=(512,1,1) lds=163840
.amdgcn_target "amdgcn-amd-amdhsa--gfx950"
.text
.globl concat_heads__ssm_conv_h3__linear_kernel_hedgehog__prompt_kernel
.p2align 8
.type concat_heads__ssm_conv_h3__linear_kernel_hedgehog__prompt_kernel,@function
concat_heads__ssm_conv_h3__linear_kernel_hedgehog__prompt_kernel:
    s_cmp_ge_u32 s2, 256
    s_cbranch_scc1 Lexit
    v_lshrrev_b32 v1, 6, v0
    s_nop 0
    v_readfirstlane_b32 s3, v1
    v_and_b32 v0, 63, v0
    s_nop 3
    s_lshl_b32 s4, s2, 3
    s_add_u32 s4, s4, s3
    s_getpc_b64 s[12:13]
Lpcbase:
    s_lshl_b32 s5, s3, 13
    v_lshlrev_b32 v4, 6, v0
    v_add_u32 v4, s5, v4
    v_min_u32 v5, Lcodeend-Lpcbase-4, v4
    v_mov_b32 v3, s13
    v_add_co_u32 v2, vcc, s12, v5
    v_addc_co_u32 v3, vcc, 0, v3, vcc
    global_load_dword v254, v[2:3], off
    v_add_u32 v4, 0x1000, v4
    v_min_u32 v5, Lcodeend-Lpcbase-4, v4
    v_mov_b32 v3, s13
    v_add_co_u32 v2, vcc, s12, v5
    v_addc_co_u32 v3, vcc, 0, v3, vcc
    global_load_dword v254, v[2:3], off
    v_add_u32 v4, 0x1000, v4
    s_load_dwordx4 s[28:31], s[0:1], 48
    s_load_dwordx2 s[32:33], s[0:1], 64
    s_load_dwordx4 s[12:15], s[0:1], 88
    s_and_b32 s38, s2, 1
    s_lshl_b32 s6, s38, 3
    s_bfe_u32 s38, s2, 0x30003
    s_add_u32 s6, s6, s38
    s_bfe_u32 s38, s2, 0x20001
    s_lshl_b32 s7, s38, 2
    s_bfe_u32 s38, s2, 0x20006
    s_add_u32 s7, s7, s38
    s_lshl_b32 s36, s6, 18
    s_lshl_b32 s37, s7, 7
    s_and_b32 s38, s3, 1
    s_lshl_b32 s39, s7, 1
    s_add_u32 s39, s39, s38
    s_mov_b32 s40, 1069066811
    v_mov_b32 v2, 163776
    v_mov_b32 v4, 0
    v_mov_b32 v5, 0
    v_mov_b32 v6, 0
    v_mov_b32 v7, 0
    ds_write_b128 v2, v[4:7]
    ds_write_b128 v2, v[4:7] offset:16
    s_waitcnt lgkmcnt(0)
    s_mov_b32 s88, s12
    s_mov_b32 s89, s13
    s_mov_b32 s90, 256
    s_mov_b32 s91, 0x00020000
    s_mov_b32 s34, s14
    s_mov_b32 s35, s15
    s_add_u32 s8, s34, 25165824
    s_addc_u32 s9, s35, 0
    s_mov_b32 s10, 16384
    s_mov_b32 s11, 0x00020000
    s_cmp_lg_u32 s4, 7
    s_cbranch_scc1 Lnoinit
    v_lshlrev_b32 v2, 8, v0
    buffer_store_dword v4, v2, s[8:11], 0 offen sc1
    s_waitcnt vmcnt(0)
    v_mov_b32 v2, 0
    v_mov_b32 v3, 1
    s_mov_b64 exec, 1
    buffer_store_dword v3, v2, s[88:91], 0 offen sc1
    s_mov_b64 exec, -1
Lnoinit:
    s_mov_b32 s12, s28
    s_mov_b32 s13, s29
    s_mov_b32 s14, 4194304
    s_mov_b32 s15, 0x00020000
    s_mov_b32 s16, s30
    s_mov_b32 s17, s31
    s_mov_b32 s18, 6291456
    s_mov_b32 s19, 0x00020000
    s_mov_b32 s20, s32
    s_mov_b32 s21, s33
    s_mov_b32 s22, 65536
    s_mov_b32 s23, 0x00020000
    s_add_u32 s24, s34, 16777216
    s_addc_u32 s25, s35, 0
    s_mov_b32 s26, 4325376
    s_mov_b32 s27, 0x00020000
    s_cmp_ge_u32 s3, 4
    s_cbranch_scc1 Lp1_loader
    v_lshlrev_b32 v2, 4, v0
    s_lshl_b32 s38, s3, 10
    s_add_u32 m0, s38, 122880
    s_lshl_b32 s41, s7, 12
    s_add_u32 s38, s38, s41
    buffer_load_dwordx4 v2, s[20:23], s38 offen lds
    v_and_b32 v5, 31, v0
    v_lshrrev_b32 v6, 1, v5
    v_and_b32 v6, 7, v6
    v_lshrrev_b32 v7, 5, v0
    v_xor_b32 v6, v6, v7
    s_bfe_u32 s42, s3, 0x10001
    s_lshl_b32 s42, s42, 13
    s_add_u32 s42, s42, 0
    v_lshlrev_b32 v5, 7, v5
    v_add_u32 v5, s42, v5
    v_xor_b32 v8, 0, v6
    v_lshl_add_u32 v8, v8, 4, v5
    v_add_u32 v12, 40960, v8
    v_add_u32 v16, 81920, v8
    v_xor_b32 v9, 2, v6
    v_lshl_add_u32 v9, v9, 4, v5
    v_add_u32 v13, 40960, v9
    v_add_u32 v17, 81920, v9
    v_xor_b32 v10, 4, v6
    v_lshl_add_u32 v10, v10, 4, v5
    v_add_u32 v14, 40960, v10
    v_add_u32 v18, 81920, v10
    v_xor_b32 v11, 6, v6
    v_lshl_add_u32 v11, v11, 4, v5
    v_add_u32 v15, 40960, v11
    v_add_u32 v19, 81920, v11
    v_lshrrev_b32 v5, 4, v0
    v_and_b32 v6, 1, v5
    v_lshlrev_b32 v6, 1, v6
    v_bfe_u32 v7, v0, 1, 1
    v_add_u32 v6, v6, v7
    s_and_b32 s42, s3, 1
    s_lshl_b32 s42, s42, 2
    v_add_u32 v6, s42, v6
    v_bfe_u32 v7, v0, 3, 1
    v_lshlrev_b32 v7, 2, v7
    v_xor_b32 v6, v6, v7
    v_lshlrev_b32 v20, 4, v6
    v_and_b32 v6, 1, v0
    v_lshl_add_u32 v20, v6, 3, v20
    v_lshrrev_b32 v5, 1, v5
    v_lshlrev_b32 v5, 3, v5
    v_bfe_u32 v6, v0, 2, 2
    v_add_u32 v5, v5, v6
    v_lshl_add_u32 v20, v5, 7, v20
    v_add_u32 v21, 40960, v20
    v_add_u32 v22, 81920, v20
    v_mov_b32 v64, 0
    v_mov_b32 v65, 0
    v_mov_b32 v66, 0
    v_mov_b32 v67, 0
    v_mov_b32 v68, 0
    v_mov_b32 v69, 0
    v_mov_b32 v70, 0
    v_mov_b32 v71, 0
    v_mov_b32 v72, 0
    v_mov_b32 v73, 0
    v_mov_b32 v74, 0
    v_mov_b32 v75, 0
    v_mov_b32 v76, 0
    v_mov_b32 v77, 0
    v_mov_b32 v78, 0
    v_mov_b32 v79, 0
    v_mov_b32 v80, 0
    v_mov_b32 v81, 0
    v_mov_b32 v82, 0
    v_mov_b32 v83, 0
    v_mov_b32 v84, 0
    v_mov_b32 v85, 0
    v_mov_b32 v86, 0
    v_mov_b32 v87, 0
    v_mov_b32 v88, 0
    v_mov_b32 v89, 0
    v_mov_b32 v90, 0
    v_mov_b32 v91, 0
    v_mov_b32 v92, 0
    v_mov_b32 v93, 0
    v_mov_b32 v94, 0
    v_mov_b32 v95, 0
    v_mov_b32 v96, 0
    v_mov_b32 v97, 0
    v_mov_b32 v98, 0
    v_mov_b32 v99, 0
    v_mov_b32 v100, 0
    v_mov_b32 v101, 0
    v_mov_b32 v102, 0
    v_mov_b32 v103, 0
    v_mov_b32 v104, 0
    v_mov_b32 v105, 0
    v_mov_b32 v106, 0
    v_mov_b32 v107, 0
    v_mov_b32 v108, 0
    v_mov_b32 v109, 0
    v_mov_b32 v110, 0
    v_mov_b32 v111, 0
    v_mov_b32 v112, 0
    v_mov_b32 v113, 0
    v_mov_b32 v114, 0
    v_mov_b32 v115, 0
    v_mov_b32 v116, 0
    v_mov_b32 v117, 0
    v_mov_b32 v118, 0
    v_mov_b32 v119, 0
    v_mov_b32 v120, 0
    v_mov_b32 v121, 0
    v_mov_b32 v122, 0
    v_mov_b32 v123, 0
    v_mov_b32 v124, 0
    v_mov_b32 v125, 0
    v_mov_b32 v126, 0
    v_mov_b32 v127, 0
    v_mov_b32 v128, 0
    v_mov_b32 v129, 0
    v_mov_b32 v130, 0
    v_mov_b32 v131, 0
    v_mov_b32 v132, 0
    v_mov_b32 v133, 0
    v_mov_b32 v134, 0
    v_mov_b32 v135, 0
    v_mov_b32 v136, 0
    v_mov_b32 v137, 0
    v_mov_b32 v138, 0
    v_mov_b32 v139, 0
    v_mov_b32 v140, 0
    v_mov_b32 v141, 0
    v_mov_b32 v142, 0
    v_mov_b32 v143, 0
    v_mov_b32 v144, 0
    v_mov_b32 v145, 0
    v_mov_b32 v146, 0
    v_mov_b32 v147, 0
    v_mov_b32 v148, 0
    v_mov_b32 v149, 0
    v_mov_b32 v150, 0
    v_mov_b32 v151, 0
    v_mov_b32 v152, 0
    v_mov_b32 v153, 0
    v_mov_b32 v154, 0
    v_mov_b32 v155, 0
    v_mov_b32 v156, 0
    v_mov_b32 v157, 0
    v_mov_b32 v158, 0
    v_mov_b32 v159, 0
    s_barrier
    ds_read_b128 v[24:27], v8 offset:0
    ds_read_b128 v[28:31], v8 offset:4096
    ds_read_b64_tr_b16 v[32:33], v20 offset:16384
    ds_read_b64_tr_b16 v[34:35], v20 offset:16896
    ds_read_b64_tr_b16 v[36:37], v20 offset:24576
    ds_read_b64_tr_b16 v[38:39], v20 offset:25088
    ds_read_b64_tr_b16 v[40:41], v20 offset:32768
    ds_read_b64_tr_b16 v[42:43], v20 offset:33280
    s_lshl_b32 s5, s2, 2
    s_add_u32 s5, s5, s3
    v_lshlrev_b32 v252, 6, v0
    s_mul_i32 s38, s5, 6144
    buffer_load_dword v253, v252, s[16:19], s38 offen
    v_and_b32 v252, 31, v0
    v_lshlrev_b32 v252, 6, v252
    s_add_u32 s38, s38, 4096
    buffer_load_dword v253, v252, s[16:19], s38 offen
    s_waitcnt lgkmcnt(0)
    v_mfma_f32_32x32x16_bf16 v[64:79], v[32:35], v[24:27], v[64:79]
    ds_read_b128 v[44:47], v9 offset:0
    ds_read_b128 v[48:51], v9 offset:4096
    v_mfma_f32_32x32x16_bf16 v[80:95], v[32:35], v[28:31], v[80:95]
    ds_read_b64_tr_b16 v[52:53], v20 offset:18432
    ds_read_b64_tr_b16 v[54:55], v20 offset:18944
    v_mfma_f32_32x32x16_bf16 v[96:111], v[36:39], v[24:27], v[96:111]
    ds_read_b64_tr_b16 v[56:57], v20 offset:26624
    ds_read_b64_tr_b16 v[58:59], v20 offset:27136
    v_mfma_f32_32x32x16_bf16 v[112:127], v[36:39], v[28:31], v[112:127]
    ds_read_b64_tr_b16 v[60:61], v20 offset:34816
    ds_read_b64_tr_b16 v[62:63], v20 offset:35328
    v_mfma_f32_32x32x16_bf16 v[128:143], v[24:27], v[40:43], v[128:143]
    v_mfma_f32_32x32x16_bf16 v[144:159], v[28:31], v[40:43], v[144:159]
    s_waitcnt lgkmcnt(0)
    v_mfma_f32_32x32x16_bf16 v[64:79], v[52:55], v[44:47], v[64:79]
    ds_read_b128 v[24:27], v10 offset:0
    ds_read_b128 v[28:31], v10 offset:4096
    v_mfma_f32_32x32x16_bf16 v[80:95], v[52:55], v[48:51], v[80:95]
    ds_read_b64_tr_b16 v[32:33], v20 offset:20480
    ds_read_b64_tr_b16 v[34:35], v20 offset:20992
    v_mfma_f32_32x32x16_bf16 v[96:111], v[56:59], v[44:47], v[96:111]
    ds_read_b64_tr_b16 v[36:37], v20 offset:28672
    ds_read_b64_tr_b16 v[38:39], v20 offset:29184
    v_mfma_f32_32x32x16_bf16 v[112:127], v[56:59], v[48:51], v[112:127]
    ds_read_b64_tr_b16 v[40:41], v20 offset:36864
    ds_read_b64_tr_b16 v[42:43], v20 offset:37376
    v_mfma_f32_32x32x16_bf16 v[128:143], v[44:47], v[60:63], v[128:143]
    v_mfma_f32_32x32x16_bf16 v[144:159], v[48:51], v[60:63], v[144:159]
    s_waitcnt lgkmcnt(0)
    v_mfma_f32_32x32x16_bf16 v[64:79], v[32:35], v[24:27], v[64:79]
    ds_read_b128 v[44:47], v11 offset:0
    ds_read_b128 v[48:51], v11 offset:4096
    v_mfma_f32_32x32x16_bf16 v[80:95], v[32:35], v[28:31], v[80:95]
    ds_read_b64_tr_b16 v[52:53], v20 offset:22528
    ds_read_b64_tr_b16 v[54:55], v20 offset:23040
    v_mfma_f32_32x32x16_bf16 v[96:111], v[36:39], v[24:27], v[96:111]
    ds_read_b64_tr_b16 v[56:57], v20 offset:30720
    ds_read_b64_tr_b16 v[58:59], v20 offset:31232
    v_mfma_f32_32x32x16_bf16 v[112:127], v[36:39], v[28:31], v[112:127]
    ds_read_b64_tr_b16 v[60:61], v20 offset:38912
    ds_read_b64_tr_b16 v[62:63], v20 offset:39424
    v_mfma_f32_32x32x16_bf16 v[128:143], v[24:27], v[40:43], v[128:143]
    v_mfma_f32_32x32x16_bf16 v[144:159], v[28:31], v[40:43], v[144:159]
    s_waitcnt lgkmcnt(0)
    s_barrier
    v_mfma_f32_32x32x16_bf16 v[64:79], v[52:55], v[44:47], v[64:79]
    ds_read_b128 v[24:27], v12 offset:0
    ds_read_b128 v[28:31], v12 offset:4096
    v_mfma_f32_32x32x16_bf16 v[80:95], v[52:55], v[48:51], v[80:95]
    ds_read_b64_tr_b16 v[32:33], v21 offset:16384
    ds_read_b64_tr_b16 v[34:35], v21 offset:16896
    v_mfma_f32_32x32x16_bf16 v[96:111], v[56:59], v[44:47], v[96:111]
    ds_read_b64_tr_b16 v[36:37], v21 offset:24576
    ds_read_b64_tr_b16 v[38:39], v21 offset:25088
    v_mfma_f32_32x32x16_bf16 v[112:127], v[56:59], v[48:51], v[112:127]
    ds_read_b64_tr_b16 v[40:41], v21 offset:32768
    ds_read_b64_tr_b16 v[42:43], v21 offset:33280
    v_mfma_f32_32x32x16_bf16 v[128:143], v[44:47], v[60:63], v[128:143]
    v_mfma_f32_32x32x16_bf16 v[144:159], v[48:51], v[60:63], v[144:159]
    s_waitcnt lgkmcnt(0)
    v_mfma_f32_32x32x16_bf16 v[64:79], v[32:35], v[24:27], v[64:79]
    ds_read_b128 v[44:47], v13 offset:0
    ds_read_b128 v[48:51], v13 offset:4096
    v_mfma_f32_32x32x16_bf16 v[80:95], v[32:35], v[28:31], v[80:95]
    ds_read_b64_tr_b16 v[52:53], v21 offset:18432
    ds_read_b64_tr_b16 v[54:55], v21 offset:18944
    v_mfma_f32_32x32x16_bf16 v[96:111], v[36:39], v[24:27], v[96:111]
    ds_read_b64_tr_b16 v[56:57], v21 offset:26624
    ds_read_b64_tr_b16 v[58:59], v21 offset:27136
    v_mfma_f32_32x32x16_bf16 v[112:127], v[36:39], v[28:31], v[112:127]
    ds_read_b64_tr_b16 v[60:61], v21 offset:34816
    ds_read_b64_tr_b16 v[62:63], v21 offset:35328
    v_mfma_f32_32x32x16_bf16 v[128:143], v[24:27], v[40:43], v[128:143]
    v_mfma_f32_32x32x16_bf16 v[144:159], v[28:31], v[40:43], v[144:159]
    s_waitcnt lgkmcnt(0)
    v_mfma_f32_32x32x16_bf16 v[64:79], v[52:55], v[44:47], v[64:79]
    ds_read_b128 v[24:27], v14 offset:0
    ds_read_b128 v[28:31], v14 offset:4096
    v_mfma_f32_32x32x16_bf16 v[80:95], v[52:55], v[48:51], v[80:95]
    ds_read_b64_tr_b16 v[32:33], v21 offset:20480
    ds_read_b64_tr_b16 v[34:35], v21 offset:20992
    v_mfma_f32_32x32x16_bf16 v[96:111], v[56:59], v[44:47], v[96:111]
    ds_read_b64_tr_b16 v[36:37], v21 offset:28672
    ds_read_b64_tr_b16 v[38:39], v21 offset:29184
    v_mfma_f32_32x32x16_bf16 v[112:127], v[56:59], v[48:51], v[112:127]
    ds_read_b64_tr_b16 v[40:41], v21 offset:36864
    ds_read_b64_tr_b16 v[42:43], v21 offset:37376
    v_mfma_f32_32x32x16_bf16 v[128:143], v[44:47], v[60:63], v[128:143]
    v_mfma_f32_32x32x16_bf16 v[144:159], v[48:51], v[60:63], v[144:159]
    s_waitcnt lgkmcnt(0)
    v_mfma_f32_32x32x16_bf16 v[64:79], v[32:35], v[24:27], v[64:79]
    ds_read_b128 v[44:47], v15 offset:0
    ds_read_b128 v[48:51], v15 offset:4096
    v_mfma_f32_32x32x16_bf16 v[80:95], v[32:35], v[28:31], v[80:95]
    ds_read_b64_tr_b16 v[52:53], v21 offset:22528
    ds_read_b64_tr_b16 v[54:55], v21 offset:23040
    v_mfma_f32_32x32x16_bf16 v[96:111], v[36:39], v[24:27], v[96:111]
    ds_read_b64_tr_b16 v[56:57], v21 offset:30720
    ds_read_b64_tr_b16 v[58:59], v21 offset:31232
    v_mfma_f32_32x32x16_bf16 v[112:127], v[36:39], v[28:31], v[112:127]
    ds_read_b64_tr_b16 v[60:61], v21 offset:38912
    ds_read_b64_tr_b16 v[62:63], v21 offset:39424
    v_mfma_f32_32x32x16_bf16 v[128:143], v[24:27], v[40:43], v[128:143]
    v_mfma_f32_32x32x16_bf16 v[144:159], v[28:31], v[40:43], v[144:159]
    s_waitcnt lgkmcnt(0)
    s_barrier
    v_mfma_f32_32x32x16_bf16 v[64:79], v[52:55], v[44:47], v[64:79]
    ds_read_b128 v[24:27], v16 offset:0
    ds_read_b128 v[28:31], v16 offset:4096
    v_mfma_f32_32x32x16_bf16 v[80:95], v[52:55], v[48:51], v[80:95]
    ds_read_b64_tr_b16 v[32:33], v22 offset:16384
    ds_read_b64_tr_b16 v[34:35], v22 offset:16896
    v_mfma_f32_32x32x16_bf16 v[96:111], v[56:59], v[44:47], v[96:111]
    ds_read_b64_tr_b16 v[36:37], v22 offset:24576
    ds_read_b64_tr_b16 v[38:39], v22 offset:25088
    v_mfma_f32_32x32x16_bf16 v[112:127], v[56:59], v[48:51], v[112:127]
    ds_read_b64_tr_b16 v[40:41], v22 offset:32768
    ds_read_b64_tr_b16 v[42:43], v22 offset:33280
    v_mfma_f32_32x32x16_bf16 v[128:143], v[44:47], v[60:63], v[128:143]
    v_mfma_f32_32x32x16_bf16 v[144:159], v[48:51], v[60:63], v[144:159]
    s_waitcnt lgkmcnt(0)
    v_mfma_f32_32x32x16_bf16 v[64:79], v[32:35], v[24:27], v[64:79]
    ds_read_b128 v[44:47], v17 offset:0
    ds_read_b128 v[48:51], v17 offset:4096
    v_mfma_f32_32x32x16_bf16 v[80:95], v[32:35], v[28:31], v[80:95]
    ds_read_b64_tr_b16 v[52:53], v22 offset:18432
    ds_read_b64_tr_b16 v[54:55], v22 offset:18944
    v_mfma_f32_32x32x16_bf16 v[96:111], v[36:39], v[24:27], v[96:111]
    ds_read_b64_tr_b16 v[56:57], v22 offset:26624
    ds_read_b64_tr_b16 v[58:59], v22 offset:27136
    v_mfma_f32_32x32x16_bf16 v[112:127], v[36:39], v[28:31], v[112:127]
    ds_read_b64_tr_b16 v[60:61], v22 offset:34816
    ds_read_b64_tr_b16 v[62:63], v22 offset:35328
    v_mfma_f32_32x32x16_bf16 v[128:143], v[24:27], v[40:43], v[128:143]
    v_mfma_f32_32x32x16_bf16 v[144:159], v[28:31], v[40:43], v[144:159]
    s_waitcnt lgkmcnt(0)
    v_mfma_f32_32x32x16_bf16 v[64:79], v[52:55], v[44:47], v[64:79]
    ds_read_b128 v[24:27], v18 offset:0
    ds_read_b128 v[28:31], v18 offset:4096
    v_mfma_f32_32x32x16_bf16 v[80:95], v[52:55], v[48:51], v[80:95]
    ds_read_b64_tr_b16 v[32:33], v22 offset:20480
    ds_read_b64_tr_b16 v[34:35], v22 offset:20992
    v_mfma_f32_32x32x16_bf16 v[96:111], v[56:59], v[44:47], v[96:111]
    ds_read_b64_tr_b16 v[36:37], v22 offset:28672
    ds_read_b64_tr_b16 v[38:39], v22 offset:29184
    v_mfma_f32_32x32x16_bf16 v[112:127], v[56:59], v[48:51], v[112:127]
    ds_read_b64_tr_b16 v[40:41], v22 offset:36864
    ds_read_b64_tr_b16 v[42:43], v22 offset:37376
    v_mfma_f32_32x32x16_bf16 v[128:143], v[44:47], v[60:63], v[128:143]
    v_mfma_f32_32x32x16_bf16 v[144:159], v[48:51], v[60:63], v[144:159]
    s_waitcnt lgkmcnt(0)
    v_mfma_f32_32x32x16_bf16 v[64:79], v[32:35], v[24:27], v[64:79]
    ds_read_b128 v[44:47], v19 offset:0
    ds_read_b128 v[48:51], v19 offset:4096
    v_mfma_f32_32x32x16_bf16 v[80:95], v[32:35], v[28:31], v[80:95]
    ds_read_b64_tr_b16 v[52:53], v22 offset:22528
    ds_read_b64_tr_b16 v[54:55], v22 offset:23040
    v_mfma_f32_32x32x16_bf16 v[96:111], v[36:39], v[24:27], v[96:111]
    ds_read_b64_tr_b16 v[56:57], v22 offset:30720
    ds_read_b64_tr_b16 v[58:59], v22 offset:31232
    v_mfma_f32_32x32x16_bf16 v[112:127], v[36:39], v[28:31], v[112:127]
    ds_read_b64_tr_b16 v[60:61], v22 offset:38912
    ds_read_b64_tr_b16 v[62:63], v22 offset:39424
    v_mfma_f32_32x32x16_bf16 v[128:143], v[24:27], v[40:43], v[128:143]
    v_mfma_f32_32x32x16_bf16 v[144:159], v[28:31], v[40:43], v[144:159]
    s_waitcnt lgkmcnt(0)
    s_barrier
    v_mfma_f32_32x32x16_bf16 v[64:79], v[52:55], v[44:47], v[64:79]
    ds_read_b128 v[24:27], v8 offset:0
    ds_read_b128 v[28:31], v8 offset:4096
    v_mfma_f32_32x32x16_bf16 v[80:95], v[52:55], v[48:51], v[80:95]
    ds_read_b64_tr_b16 v[32:33], v20 offset:16384
    ds_read_b64_tr_b16 v[34:35], v20 offset:16896
    v_mfma_f32_32x32x16_bf16 v[96:111], v[56:59], v[44:47], v[96:111]
    ds_read_b64_tr_b16 v[36:37], v20 offset:24576
    ds_read_b64_tr_b16 v[38:39], v20 offset:25088
    v_mfma_f32_32x32x16_bf16 v[112:127], v[56:59], v[48:51], v[112:127]
    ds_read_b64_tr_b16 v[40:41], v20 offset:32768
    ds_read_b64_tr_b16 v[42:43], v20 offset:33280
    v_mfma_f32_32x32x16_bf16 v[128:143], v[44:47], v[60:63], v[128:143]
    v_mfma_f32_32x32x16_bf16 v[144:159], v[48:51], v[60:63], v[144:159]
    s_waitcnt lgkmcnt(0)
    v_mfma_f32_32x32x16_bf16 v[64:79], v[32:35], v[24:27], v[64:79]
    ds_read_b128 v[44:47], v9 offset:0
    ds_read_b128 v[48:51], v9 offset:4096
    v_mfma_f32_32x32x16_bf16 v[80:95], v[32:35], v[28:31], v[80:95]
    ds_read_b64_tr_b16 v[52:53], v20 offset:18432
    ds_read_b64_tr_b16 v[54:55], v20 offset:18944
    v_mfma_f32_32x32x16_bf16 v[96:111], v[36:39], v[24:27], v[96:111]
    ds_read_b64_tr_b16 v[56:57], v20 offset:26624
    ds_read_b64_tr_b16 v[58:59], v20 offset:27136
    v_mfma_f32_32x32x16_bf16 v[112:127], v[36:39], v[28:31], v[112:127]
    ds_read_b64_tr_b16 v[60:61], v20 offset:34816
    ds_read_b64_tr_b16 v[62:63], v20 offset:35328
    v_mfma_f32_32x32x16_bf16 v[128:143], v[24:27], v[40:43], v[128:143]
    v_mfma_f32_32x32x16_bf16 v[144:159], v[28:31], v[40:43], v[144:159]
    s_waitcnt lgkmcnt(0)
    v_mfma_f32_32x32x16_bf16 v[64:79], v[52:55], v[44:47], v[64:79]
    ds_read_b128 v[24:27], v10 offset:0
    ds_read_b128 v[28:31], v10 offset:4096
    v_mfma_f32_32x32x16_bf16 v[80:95], v[52:55], v[48:51], v[80:95]
    ds_read_b64_tr_b16 v[32:33], v20 offset:20480
    ds_read_b64_tr_b16 v[34:35], v20 offset:20992
    v_mfma_f32_32x32x16_bf16 v[96:111], v[56:59], v[44:47], v[96:111]
    ds_read_b64_tr_b16 v[36:37], v20 offset:28672
    ds_read_b64_tr_b16 v[38:39], v20 offset:29184
    v_mfma_f32_32x32x16_bf16 v[112:127], v[56:59], v[48:51], v[112:127]
    ds_read_b64_tr_b16 v[40:41], v20 offset:36864
    ds_read_b64_tr_b16 v[42:43], v20 offset:37376
    v_mfma_f32_32x32x16_bf16 v[128:143], v[44:47], v[60:63], v[128:143]
    v_mfma_f32_32x32x16_bf16 v[144:159], v[48:51], v[60:63], v[144:159]
    s_waitcnt lgkmcnt(0)
    v_mfma_f32_32x32x16_bf16 v[64:79], v[32:35], v[24:27], v[64:79]
    ds_read_b128 v[44:47], v11 offset:0
    ds_read_b128 v[48:51], v11 offset:4096
    v_mfma_f32_32x32x16_bf16 v[80:95], v[32:35], v[28:31], v[80:95]
    ds_read_b64_tr_b16 v[52:53], v20 offset:22528
    ds_read_b64_tr_b16 v[54:55], v20 offset:23040
    v_mfma_f32_32x32x16_bf16 v[96:111], v[36:39], v[24:27], v[96:111]
    ds_read_b64_tr_b16 v[56:57], v20 offset:30720
    ds_read_b64_tr_b16 v[58:59], v20 offset:31232
    v_mfma_f32_32x32x16_bf16 v[112:127], v[36:39], v[28:31], v[112:127]
    ds_read_b64_tr_b16 v[60:61], v20 offset:38912
    ds_read_b64_tr_b16 v[62:63], v20 offset:39424
    v_mfma_f32_32x32x16_bf16 v[128:143], v[24:27], v[40:43], v[128:143]
    v_mfma_f32_32x32x16_bf16 v[144:159], v[28:31], v[40:43], v[144:159]
    s_waitcnt lgkmcnt(0)
    s_barrier
    v_mfma_f32_32x32x16_bf16 v[64:79], v[52:55], v[44:47], v[64:79]
    ds_read_b128 v[24:27], v12 offset:0
    ds_read_b128 v[28:31], v12 offset:4096
    v_mfma_f32_32x32x16_bf16 v[80:95], v[52:55], v[48:51], v[80:95]
    ds_read_b64_tr_b16 v[32:33], v21 offset:16384
    ds_read_b64_tr_b16 v[34:35], v21 offset:16896
    v_mfma_f32_32x32x16_bf16 v[96:111], v[56:59], v[44:47], v[96:111]
    ds_read_b64_tr_b16 v[36:37], v21 offset:24576
    ds_read_b64_tr_b16 v[38:39], v21 offset:25088
    v_mfma_f32_32x32x16_bf16 v[112:127], v[56:59], v[48:51], v[112:127]
    ds_read_b64_tr_b16 v[40:41], v21 offset:32768
    ds_read_b64_tr_b16 v[42:43], v21 offset:33280
    v_mfma_f32_32x32x16_bf16 v[128:143], v[44:47], v[60:63], v[128:143]
    v_mfma_f32_32x32x16_bf16 v[144:159], v[48:51], v[60:63], v[144:159]
    s_waitcnt lgkmcnt(0)
    v_mfma_f32_32x32x16_bf16 v[64:79], v[32:35], v[24:27], v[64:79]
    ds_read_b128 v[44:47], v13 offset:0
    ds_read_b128 v[48:51], v13 offset:4096
    v_mfma_f32_32x32x16_bf16 v[80:95], v[32:35], v[28:31], v[80:95]
    ds_read_b64_tr_b16 v[52:53], v21 offset:18432
    ds_read_b64_tr_b16 v[54:55], v21 offset:18944
    v_mfma_f32_32x32x16_bf16 v[96:111], v[36:39], v[24:27], v[96:111]
    ds_read_b64_tr_b16 v[56:57], v21 offset:26624
    ds_read_b64_tr_b16 v[58:59], v21 offset:27136
    v_mfma_f32_32x32x16_bf16 v[112:127], v[36:39], v[28:31], v[112:127]
    ds_read_b64_tr_b16 v[60:61], v21 offset:34816
    ds_read_b64_tr_b16 v[62:63], v21 offset:35328
    v_mfma_f32_32x32x16_bf16 v[128:143], v[24:27], v[40:43], v[128:143]
    v_mfma_f32_32x32x16_bf16 v[144:159], v[28:31], v[40:43], v[144:159]
    s_waitcnt lgkmcnt(0)
    v_mfma_f32_32x32x16_bf16 v[64:79], v[52:55], v[44:47], v[64:79]
    ds_read_b128 v[24:27], v14 offset:0
    ds_read_b128 v[28:31], v14 offset:4096
    v_mfma_f32_32x32x16_bf16 v[80:95], v[52:55], v[48:51], v[80:95]
    ds_read_b64_tr_b16 v[32:33], v21 offset:20480
    ds_read_b64_tr_b16 v[34:35], v21 offset:20992
    v_mfma_f32_32x32x16_bf16 v[96:111], v[56:59], v[44:47], v[96:111]
    ds_read_b64_tr_b16 v[36:37], v21 offset:28672
    ds_read_b64_tr_b16 v[38:39], v21 offset:29184
    v_mfma_f32_32x32x16_bf16 v[112:127], v[56:59], v[48:51], v[112:127]
    ds_read_b64_tr_b16 v[40:41], v21 offset:36864
    ds_read_b64_tr_b16 v[42:43], v21 offset:37376
    v_mfma_f32_32x32x16_bf16 v[128:143], v[44:47], v[60:63], v[128:143]
    v_mfma_f32_32x32x16_bf16 v[144:159], v[48:51], v[60:63], v[144:159]
    s_waitcnt lgkmcnt(0)
    v_mfma_f32_32x32x16_bf16 v[64:79], v[32:35], v[24:27], v[64:79]
    ds_read_b128 v[44:47], v15 offset:0
    ds_read_b128 v[48:51], v15 offset:4096
    v_mfma_f32_32x32x16_bf16 v[80:95], v[32:35], v[28:31], v[80:95]
    ds_read_b64_tr_b16 v[52:53], v21 offset:22528
    ds_read_b64_tr_b16 v[54:55], v21 offset:23040
    v_mfma_f32_32x32x16_bf16 v[96:111], v[36:39], v[24:27], v[96:111]
    ds_read_b64_tr_b16 v[56:57], v21 offset:30720
    ds_read_b64_tr_b16 v[58:59], v21 offset:31232
    v_mfma_f32_32x32x16_bf16 v[112:127], v[36:39], v[28:31], v[112:127]
    ds_read_b64_tr_b16 v[60:61], v21 offset:38912
    ds_read_b64_tr_b16 v[62:63], v21 offset:39424
    v_mfma_f32_32x32x16_bf16 v[128:143], v[24:27], v[40:43], v[128:143]
    v_mfma_f32_32x32x16_bf16 v[144:159], v[28:31], v[40:43], v[144:159]
    s_waitcnt lgkmcnt(0)
    s_barrier
    v_mfma_f32_32x32x16_bf16 v[64:79], v[52:55], v[44:47], v[64:79]
    ds_read_b128 v[24:27], v16 offset:0
    ds_read_b128 v[28:31], v16 offset:4096
    v_mfma_f32_32x32x16_bf16 v[80:95], v[52:55], v[48:51], v[80:95]
    ds_read_b64_tr_b16 v[32:33], v22 offset:16384
    ds_read_b64_tr_b16 v[34:35], v22 offset:16896
    v_mfma_f32_32x32x16_bf16 v[96:111], v[56:59], v[44:47], v[96:111]
    ds_read_b64_tr_b16 v[36:37], v22 offset:24576
    ds_read_b64_tr_b16 v[38:39], v22 offset:25088
    v_mfma_f32_32x32x16_bf16 v[112:127], v[56:59], v[48:51], v[112:127]
    ds_read_b64_tr_b16 v[40:41], v22 offset:32768
    ds_read_b64_tr_b16 v[42:43], v22 offset:33280
    v_mfma_f32_32x32x16_bf16 v[128:143], v[44:47], v[60:63], v[128:143]
    v_mfma_f32_32x32x16_bf16 v[144:159], v[48:51], v[60:63], v[144:159]
    s_waitcnt lgkmcnt(0)
    v_mfma_f32_32x32x16_bf16 v[64:79], v[32:35], v[24:27], v[64:79]
    ds_read_b128 v[44:47], v17 offset:0
    ds_read_b128 v[48:51], v17 offset:4096
    v_mfma_f32_32x32x16_bf16 v[80:95], v[32:35], v[28:31], v[80:95]
    ds_read_b64_tr_b16 v[52:53], v22 offset:18432
    ds_read_b64_tr_b16 v[54:55], v22 offset:18944
    v_mfma_f32_32x32x16_bf16 v[96:111], v[36:39], v[24:27], v[96:111]
    ds_read_b64_tr_b16 v[56:57], v22 offset:26624
    ds_read_b64_tr_b16 v[58:59], v22 offset:27136
    v_mfma_f32_32x32x16_bf16 v[112:127], v[36:39], v[28:31], v[112:127]
    ds_read_b64_tr_b16 v[60:61], v22 offset:34816
    ds_read_b64_tr_b16 v[62:63], v22 offset:35328
    v_mfma_f32_32x32x16_bf16 v[128:143], v[24:27], v[40:43], v[128:143]
    v_mfma_f32_32x32x16_bf16 v[144:159], v[28:31], v[40:43], v[144:159]
    s_waitcnt lgkmcnt(0)
    v_mfma_f32_32x32x16_bf16 v[64:79], v[52:55], v[44:47], v[64:79]
    ds_read_b128 v[24:27], v18 offset:0
    ds_read_b128 v[28:31], v18 offset:4096
    v_mfma_f32_32x32x16_bf16 v[80:95], v[52:55], v[48:51], v[80:95]
    ds_read_b64_tr_b16 v[32:33], v22 offset:20480
    ds_read_b64_tr_b16 v[34:35], v22 offset:20992
    v_mfma_f32_32x32x16_bf16 v[96:111], v[56:59], v[44:47], v[96:111]
    ds_read_b64_tr_b16 v[36:37], v22 offset:28672
    ds_read_b64_tr_b16 v[38:39], v22 offset:29184
    v_mfma_f32_32x32x16_bf16 v[112:127], v[56:59], v[48:51], v[112:127]
    ds_read_b64_tr_b16 v[40:41], v22 offset:36864
    ds_read_b64_tr_b16 v[42:43], v22 offset:37376
    v_mfma_f32_32x32x16_bf16 v[128:143], v[44:47], v[60:63], v[128:143]
    v_mfma_f32_32x32x16_bf16 v[144:159], v[48:51], v[60:63], v[144:159]
    s_waitcnt lgkmcnt(0)
    v_mfma_f32_32x32x16_bf16 v[64:79], v[32:35], v[24:27], v[64:79]
    ds_read_b128 v[44:47], v19 offset:0
    ds_read_b128 v[48:51], v19 offset:4096
    v_mfma_f32_32x32x16_bf16 v[80:95], v[32:35], v[28:31], v[80:95]
    ds_read_b64_tr_b16 v[52:53], v22 offset:22528
    ds_read_b64_tr_b16 v[54:55], v22 offset:23040
    v_mfma_f32_32x32x16_bf16 v[96:111], v[36:39], v[24:27], v[96:111]
    ds_read_b64_tr_b16 v[56:57], v22 offset:30720
    ds_read_b64_tr_b16 v[58:59], v22 offset:31232
    v_mfma_f32_32x32x16_bf16 v[112:127], v[36:39], v[28:31], v[112:127]
    ds_read_b64_tr_b16 v[60:61], v22 offset:38912
    ds_read_b64_tr_b16 v[62:63], v22 offset:39424
    v_mfma_f32_32x32x16_bf16 v[128:143], v[24:27], v[40:43], v[128:143]
    v_mfma_f32_32x32x16_bf16 v[144:159], v[28:31], v[40:43], v[144:159]
    s_waitcnt lgkmcnt(0)
    s_barrier
    v_mfma_f32_32x32x16_bf16 v[64:79], v[52:55], v[44:47], v[64:79]
    ds_read_b128 v[24:27], v8 offset:0
    ds_read_b128 v[28:31], v8 offset:4096
    v_mfma_f32_32x32x16_bf16 v[80:95], v[52:55], v[48:51], v[80:95]
    ds_read_b64_tr_b16 v[32:33], v20 offset:16384
    ds_read_b64_tr_b16 v[34:35], v20 offset:16896
    v_mfma_f32_32x32x16_bf16 v[96:111], v[56:59], v[44:47], v[96:111]
    ds_read_b64_tr_b16 v[36:37], v20 offset:24576
    ds_read_b64_tr_b16 v[38:39], v20 offset:25088
    v_mfma_f32_32x32x16_bf16 v[112:127], v[56:59], v[48:51], v[112:127]
    ds_read_b64_tr_b16 v[40:41], v20 offset:32768
    ds_read_b64_tr_b16 v[42:43], v20 offset:33280
    v_mfma_f32_32x32x16_bf16 v[128:143], v[44:47], v[60:63], v[128:143]
    v_mfma_f32_32x32x16_bf16 v[144:159], v[48:51], v[60:63], v[144:159]
    s_waitcnt lgkmcnt(0)
    v_mfma_f32_32x32x16_bf16 v[64:79], v[32:35], v[24:27], v[64:79]
    ds_read_b128 v[44:47], v9 offset:0
    ds_read_b128 v[48:51], v9 offset:4096
    v_mfma_f32_32x32x16_bf16 v[80:95], v[32:35], v[28:31], v[80:95]
    ds_read_b64_tr_b16 v[52:53], v20 offset:18432
    ds_read_b64_tr_b16 v[54:55], v20 offset:18944
    v_mfma_f32_32x32x16_bf16 v[96:111], v[36:39], v[24:27], v[96:111]
    ds_read_b64_tr_b16 v[56:57], v20 offset:26624
    ds_read_b64_tr_b16 v[58:59], v20 offset:27136
    v_mfma_f32_32x32x16_bf16 v[112:127], v[36:39], v[28:31], v[112:127]
    ds_read_b64_tr_b16 v[60:61], v20 offset:34816
    ds_read_b64_tr_b16 v[62:63], v20 offset:35328
    v_mfma_f32_32x32x16_bf16 v[128:143], v[24:27], v[40:43], v[128:143]
    v_mfma_f32_32x32x16_bf16 v[144:159], v[28:31], v[40:43], v[144:159]
    s_waitcnt lgkmcnt(0)
    v_mfma_f32_32x32x16_bf16 v[64:79], v[52:55], v[44:47], v[64:79]
    ds_read_b128 v[24:27], v10 offset:0
    ds_read_b128 v[28:31], v10 offset:4096
    v_mfma_f32_32x32x16_bf16 v[80:95], v[52:55], v[48:51], v[80:95]
    ds_read_b64_tr_b16 v[32:33], v20 offset:20480
    ds_read_b64_tr_b16 v[34:35], v20 offset:20992
    v_mfma_f32_32x32x16_bf16 v[96:111], v[56:59], v[44:47], v[96:111]
    ds_read_b64_tr_b16 v[36:37], v20 offset:28672
    ds_read_b64_tr_b16 v[38:39], v20 offset:29184
    v_mfma_f32_32x32x16_bf16 v[112:127], v[56:59], v[48:51], v[112:127]
    ds_read_b64_tr_b16 v[40:41], v20 offset:36864
    ds_read_b64_tr_b16 v[42:43], v20 offset:37376
    v_mfma_f32_32x32x16_bf16 v[128:143], v[44:47], v[60:63], v[128:143]
    v_mfma_f32_32x32x16_bf16 v[144:159], v[48:51], v[60:63], v[144:159]
    s_waitcnt lgkmcnt(0)
    v_mfma_f32_32x32x16_bf16 v[64:79], v[32:35], v[24:27], v[64:79]
    ds_read_b128 v[44:47], v11 offset:0
    ds_read_b128 v[48:51], v11 offset:4096
    v_mfma_f32_32x32x16_bf16 v[80:95], v[32:35], v[28:31], v[80:95]
    ds_read_b64_tr_b16 v[52:53], v20 offset:22528
    ds_read_b64_tr_b16 v[54:55], v20 offset:23040
    v_mfma_f32_32x32x16_bf16 v[96:111], v[36:39], v[24:27], v[96:111]
    ds_read_b64_tr_b16 v[56:57], v20 offset:30720
    ds_read_b64_tr_b16 v[58:59], v20 offset:31232
    v_mfma_f32_32x32x16_bf16 v[112:127], v[36:39], v[28:31], v[112:127]
    ds_read_b64_tr_b16 v[60:61], v20 offset:38912
    ds_read_b64_tr_b16 v[62:63], v20 offset:39424
    v_mfma_f32_32x32x16_bf16 v[128:143], v[24:27], v[40:43], v[128:143]
    v_mfma_f32_32x32x16_bf16 v[144:159], v[28:31], v[40:43], v[144:159]
    s_waitcnt lgkmcnt(0)
    s_barrier
    v_mfma_f32_32x32x16_bf16 v[64:79], v[52:55], v[44:47], v[64:79]
    ds_read_b128 v[24:27], v12 offset:0
    ds_read_b128 v[28:31], v12 offset:4096
    v_mfma_f32_32x32x16_bf16 v[80:95], v[52:55], v[48:51], v[80:95]
    ds_read_b64_tr_b16 v[32:33], v21 offset:16384
    ds_read_b64_tr_b16 v[34:35], v21 offset:16896
    v_mfma_f32_32x32x16_bf16 v[96:111], v[56:59], v[44:47], v[96:111]
    ds_read_b64_tr_b16 v[36:37], v21 offset:24576
    ds_read_b64_tr_b16 v[38:39], v21 offset:25088
    v_mfma_f32_32x32x16_bf16 v[112:127], v[56:59], v[48:51], v[112:127]
    ds_read_b64_tr_b16 v[40:41], v21 offset:32768
    ds_read_b64_tr_b16 v[42:43], v21 offset:33280
    v_mfma_f32_32x32x16_bf16 v[128:143], v[44:47], v[60:63], v[128:143]
    v_mfma_f32_32x32x16_bf16 v[144:159], v[48:51], v[60:63], v[144:159]
    s_waitcnt lgkmcnt(0)
    v_mfma_f32_32x32x16_bf16 v[64:79], v[32:35], v[24:27], v[64:79]
    ds_read_b128 v[44:47], v13 offset:0
    ds_read_b128 v[48:51], v13 offset:4096
    v_mfma_f32_32x32x16_bf16 v[80:95], v[32:35], v[28:31], v[80:95]
    ds_read_b64_tr_b16 v[52:53], v21 offset:18432
    ds_read_b64_tr_b16 v[54:55], v21 offset:18944
    v_mfma_f32_32x32x16_bf16 v[96:111], v[36:39], v[24:27], v[96:111]
    ds_read_b64_tr_b16 v[56:57], v21 offset:26624
    ds_read_b64_tr_b16 v[58:59], v21 offset:27136
    v_mfma_f32_32x32x16_bf16 v[112:127], v[36:39], v[28:31], v[112:127]
    ds_read_b64_tr_b16 v[60:61], v21 offset:34816
    ds_read_b64_tr_b16 v[62:63], v21 offset:35328
    v_mfma_f32_32x32x16_bf16 v[128:143], v[24:27], v[40:43], v[128:143]
    v_mfma_f32_32x32x16_bf16 v[144:159], v[28:31], v[40:43], v[144:159]
    s_waitcnt lgkmcnt(0)
    v_mfma_f32_32x32x16_bf16 v[64:79], v[52:55], v[44:47], v[64:79]
    ds_read_b128 v[24:27], v14 offset:0
    ds_read_b128 v[28:31], v14 offset:4096
    v_mfma_f32_32x32x16_bf16 v[80:95], v[52:55], v[48:51], v[80:95]
    ds_read_b64_tr_b16 v[32:33], v21 offset:20480
    ds_read_b64_tr_b16 v[34:35], v21 offset:20992
    v_mfma_f32_32x32x16_bf16 v[96:111], v[56:59], v[44:47], v[96:111]
    ds_read_b64_tr_b16 v[36:37], v21 offset:28672
    ds_read_b64_tr_b16 v[38:39], v21 offset:29184
    v_mfma_f32_32x32x16_bf16 v[112:127], v[56:59], v[48:51], v[112:127]
    ds_read_b64_tr_b16 v[40:41], v21 offset:36864
    ds_read_b64_tr_b16 v[42:43], v21 offset:37376
    v_mfma_f32_32x32x16_bf16 v[128:143], v[44:47], v[60:63], v[128:143]
    v_mfma_f32_32x32x16_bf16 v[144:159], v[48:51], v[60:63], v[144:159]
    s_waitcnt lgkmcnt(0)
    v_mfma_f32_32x32x16_bf16 v[64:79], v[32:35], v[24:27], v[64:79]
    ds_read_b128 v[44:47], v15 offset:0
    ds_read_b128 v[48:51], v15 offset:4096
    v_mfma_f32_32x32x16_bf16 v[80:95], v[32:35], v[28:31], v[80:95]
    ds_read_b64_tr_b16 v[52:53], v21 offset:22528
    ds_read_b64_tr_b16 v[54:55], v21 offset:23040
    v_mfma_f32_32x32x16_bf16 v[96:111], v[36:39], v[24:27], v[96:111]
    ds_read_b64_tr_b16 v[56:57], v21 offset:30720
    ds_read_b64_tr_b16 v[58:59], v21 offset:31232
    v_mfma_f32_32x32x16_bf16 v[112:127], v[36:39], v[28:31], v[112:127]
    ds_read_b64_tr_b16 v[60:61], v21 offset:38912
    ds_read_b64_tr_b16 v[62:63], v21 offset:39424
    v_mfma_f32_32x32x16_bf16 v[128:143], v[24:27], v[40:43], v[128:143]
    v_mfma_f32_32x32x16_bf16 v[144:159], v[28:31], v[40:43], v[144:159]
    s_waitcnt lgkmcnt(0)
    s_barrier
    v_mfma_f32_32x32x16_bf16 v[64:79], v[52:55], v[44:47], v[64:79]
    ds_read_b128 v[24:27], v16 offset:0
    ds_read_b128 v[28:31], v16 offset:4096
    v_mfma_f32_32x32x16_bf16 v[80:95], v[52:55], v[48:51], v[80:95]
    ds_read_b64_tr_b16 v[32:33], v22 offset:16384
    ds_read_b64_tr_b16 v[34:35], v22 offset:16896
    v_mfma_f32_32x32x16_bf16 v[96:111], v[56:59], v[44:47], v[96:111]
    ds_read_b64_tr_b16 v[36:37], v22 offset:24576
    ds_read_b64_tr_b16 v[38:39], v22 offset:25088
    v_mfma_f32_32x32x16_bf16 v[112:127], v[56:59], v[48:51], v[112:127]
    ds_read_b64_tr_b16 v[40:41], v22 offset:32768
    ds_read_b64_tr_b16 v[42:43], v22 offset:33280
    v_mfma_f32_32x32x16_bf16 v[128:143], v[44:47], v[60:63], v[128:143]
    v_mfma_f32_32x32x16_bf16 v[144:159], v[48:51], v[60:63], v[144:159]
    s_waitcnt lgkmcnt(0)
    v_mfma_f32_32x32x16_bf16 v[64:79], v[32:35], v[24:27], v[64:79]
    ds_read_b128 v[44:47], v17 offset:0
    ds_read_b128 v[48:51], v17 offset:4096
    v_mfma_f32_32x32x16_bf16 v[80:95], v[32:35], v[28:31], v[80:95]
    ds_read_b64_tr_b16 v[52:53], v22 offset:18432
    ds_read_b64_tr_b16 v[54:55], v22 offset:18944
    v_mfma_f32_32x32x16_bf16 v[96:111], v[36:39], v[24:27], v[96:111]
    ds_read_b64_tr_b16 v[56:57], v22 offset:26624
    ds_read_b64_tr_b16 v[58:59], v22 offset:27136
    v_mfma_f32_32x32x16_bf16 v[112:127], v[36:39], v[28:31], v[112:127]
    ds_read_b64_tr_b16 v[60:61], v22 offset:34816
    ds_read_b64_tr_b16 v[62:63], v22 offset:35328
    v_mfma_f32_32x32x16_bf16 v[128:143], v[24:27], v[40:43], v[128:143]
    v_mfma_f32_32x32x16_bf16 v[144:159], v[28:31], v[40:43], v[144:159]
    s_waitcnt lgkmcnt(0)
    v_mfma_f32_32x32x16_bf16 v[64:79], v[52:55], v[44:47], v[64:79]
    ds_read_b128 v[24:27], v18 offset:0
    ds_read_b128 v[28:31], v18 offset:4096
    v_mfma_f32_32x32x16_bf16 v[80:95], v[52:55], v[48:51], v[80:95]
    ds_read_b64_tr_b16 v[32:33], v22 offset:20480
    ds_read_b64_tr_b16 v[34:35], v22 offset:20992
    v_mfma_f32_32x32x16_bf16 v[96:111], v[56:59], v[44:47], v[96:111]
    ds_read_b64_tr_b16 v[36:37], v22 offset:28672
    ds_read_b64_tr_b16 v[38:39], v22 offset:29184
    v_mfma_f32_32x32x16_bf16 v[112:127], v[56:59], v[48:51], v[112:127]
    ds_read_b64_tr_b16 v[40:41], v22 offset:36864
    ds_read_b64_tr_b16 v[42:43], v22 offset:37376
    v_mfma_f32_32x32x16_bf16 v[128:143], v[44:47], v[60:63], v[128:143]
    v_mfma_f32_32x32x16_bf16 v[144:159], v[48:51], v[60:63], v[144:159]
    s_waitcnt lgkmcnt(0)
    v_mfma_f32_32x32x16_bf16 v[64:79], v[32:35], v[24:27], v[64:79]
    ds_read_b128 v[44:47], v19 offset:0
    ds_read_b128 v[48:51], v19 offset:4096
    v_mfma_f32_32x32x16_bf16 v[80:95], v[32:35], v[28:31], v[80:95]
    ds_read_b64_tr_b16 v[52:53], v22 offset:22528
    ds_read_b64_tr_b16 v[54:55], v22 offset:23040
    v_mfma_f32_32x32x16_bf16 v[96:111], v[36:39], v[24:27], v[96:111]
    ds_read_b64_tr_b16 v[56:57], v22 offset:30720
    ds_read_b64_tr_b16 v[58:59], v22 offset:31232
    v_mfma_f32_32x32x16_bf16 v[112:127], v[36:39], v[28:31], v[112:127]
    ds_read_b64_tr_b16 v[60:61], v22 offset:38912
    ds_read_b64_tr_b16 v[62:63], v22 offset:39424
    v_mfma_f32_32x32x16_bf16 v[128:143], v[24:27], v[40:43], v[128:143]
    v_mfma_f32_32x32x16_bf16 v[144:159], v[28:31], v[40:43], v[144:159]
    s_waitcnt lgkmcnt(0)
    s_barrier
    v_mfma_f32_32x32x16_bf16 v[64:79], v[52:55], v[44:47], v[64:79]
    ds_read_b128 v[24:27], v8 offset:0
    ds_read_b128 v[28:31], v8 offset:4096
    v_mfma_f32_32x32x16_bf16 v[80:95], v[52:55], v[48:51], v[80:95]
    ds_read_b64_tr_b16 v[32:33], v20 offset:16384
    ds_read_b64_tr_b16 v[34:35], v20 offset:16896
    v_mfma_f32_32x32x16_bf16 v[96:111], v[56:59], v[44:47], v[96:111]
    ds_read_b64_tr_b16 v[36:37], v20 offset:24576
    ds_read_b64_tr_b16 v[38:39], v20 offset:25088
    v_mfma_f32_32x32x16_bf16 v[112:127], v[56:59], v[48:51], v[112:127]
    ds_read_b64_tr_b16 v[40:41], v20 offset:32768
    ds_read_b64_tr_b16 v[42:43], v20 offset:33280
    v_mfma_f32_32x32x16_bf16 v[128:143], v[44:47], v[60:63], v[128:143]
    v_mfma_f32_32x32x16_bf16 v[144:159], v[48:51], v[60:63], v[144:159]
    s_waitcnt lgkmcnt(0)
    v_mfma_f32_32x32x16_bf16 v[64:79], v[32:35], v[24:27], v[64:79]
    ds_read_b128 v[44:47], v9 offset:0
    ds_read_b128 v[48:51], v9 offset:4096
    v_mfma_f32_32x32x16_bf16 v[80:95], v[32:35], v[28:31], v[80:95]
    ds_read_b64_tr_b16 v[52:53], v20 offset:18432
    ds_read_b64_tr_b16 v[54:55], v20 offset:18944
    v_mfma_f32_32x32x16_bf16 v[96:111], v[36:39], v[24:27], v[96:111]
    ds_read_b64_tr_b16 v[56:57], v20 offset:26624
    ds_read_b64_tr_b16 v[58:59], v20 offset:27136
    v_mfma_f32_32x32x16_bf16 v[112:127], v[36:39], v[28:31], v[112:127]
    ds_read_b64_tr_b16 v[60:61], v20 offset:34816
    ds_read_b64_tr_b16 v[62:63], v20 offset:35328
    v_mfma_f32_32x32x16_bf16 v[128:143], v[24:27], v[40:43], v[128:143]
    v_mfma_f32_32x32x16_bf16 v[144:159], v[28:31], v[40:43], v[144:159]
    s_waitcnt lgkmcnt(0)
    v_mfma_f32_32x32x16_bf16 v[64:79], v[52:55], v[44:47], v[64:79]
    ds_read_b128 v[24:27], v10 offset:0
    ds_read_b128 v[28:31], v10 offset:4096
    v_mfma_f32_32x32x16_bf16 v[80:95], v[52:55], v[48:51], v[80:95]
    ds_read_b64_tr_b16 v[32:33], v20 offset:20480
    ds_read_b64_tr_b16 v[34:35], v20 offset:20992
    v_mfma_f32_32x32x16_bf16 v[96:111], v[56:59], v[44:47], v[96:111]
    ds_read_b64_tr_b16 v[36:37], v20 offset:28672
    ds_read_b64_tr_b16 v[38:39], v20 offset:29184
    v_mfma_f32_32x32x16_bf16 v[112:127], v[56:59], v[48:51], v[112:127]
    ds_read_b64_tr_b16 v[40:41], v20 offset:36864
    ds_read_b64_tr_b16 v[42:43], v20 offset:37376
    v_mfma_f32_32x32x16_bf16 v[128:143], v[44:47], v[60:63], v[128:143]
    v_mfma_f32_32x32x16_bf16 v[144:159], v[48:51], v[60:63], v[144:159]
    s_waitcnt lgkmcnt(0)
    v_mfma_f32_32x32x16_bf16 v[64:79], v[32:35], v[24:27], v[64:79]
    ds_read_b128 v[44:47], v11 offset:0
    ds_read_b128 v[48:51], v11 offset:4096
    v_mfma_f32_32x32x16_bf16 v[80:95], v[32:35], v[28:31], v[80:95]
    ds_read_b64_tr_b16 v[52:53], v20 offset:22528
    ds_read_b64_tr_b16 v[54:55], v20 offset:23040
    v_mfma_f32_32x32x16_bf16 v[96:111], v[36:39], v[24:27], v[96:111]
    ds_read_b64_tr_b16 v[56:57], v20 offset:30720
    ds_read_b64_tr_b16 v[58:59], v20 offset:31232
    v_mfma_f32_32x32x16_bf16 v[112:127], v[36:39], v[28:31], v[112:127]
    ds_read_b64_tr_b16 v[60:61], v20 offset:38912
    ds_read_b64_tr_b16 v[62:63], v20 offset:39424
    v_mfma_f32_32x32x16_bf16 v[128:143], v[24:27], v[40:43], v[128:143]
    v_mfma_f32_32x32x16_bf16 v[144:159], v[28:31], v[40:43], v[144:159]
    s_waitcnt lgkmcnt(0)
    s_barrier
    v_mfma_f32_32x32x16_bf16 v[64:79], v[52:55], v[44:47], v[64:79]
    ds_read_b128 v[24:27], v12 offset:0
    ds_read_b128 v[28:31], v12 offset:4096
    v_mfma_f32_32x32x16_bf16 v[80:95], v[52:55], v[48:51], v[80:95]
    ds_read_b64_tr_b16 v[32:33], v21 offset:16384
    ds_read_b64_tr_b16 v[34:35], v21 offset:16896
    v_mfma_f32_32x32x16_bf16 v[96:111], v[56:59], v[44:47], v[96:111]
    ds_read_b64_tr_b16 v[36:37], v21 offset:24576
    ds_read_b64_tr_b16 v[38:39], v21 offset:25088
    v_mfma_f32_32x32x16_bf16 v[112:127], v[56:59], v[48:51], v[112:127]
    ds_read_b64_tr_b16 v[40:41], v21 offset:32768
    ds_read_b64_tr_b16 v[42:43], v21 offset:33280
    v_mfma_f32_32x32x16_bf16 v[128:143], v[44:47], v[60:63], v[128:143]
    v_mfma_f32_32x32x16_bf16 v[144:159], v[48:51], v[60:63], v[144:159]
    s_waitcnt lgkmcnt(0)
    v_mfma_f32_32x32x16_bf16 v[64:79], v[32:35], v[24:27], v[64:79]
    ds_read_b128 v[44:47], v13 offset:0
    ds_read_b128 v[48:51], v13 offset:4096
    v_mfma_f32_32x32x16_bf16 v[80:95], v[32:35], v[28:31], v[80:95]
    ds_read_b64_tr_b16 v[52:53], v21 offset:18432
    ds_read_b64_tr_b16 v[54:55], v21 offset:18944
    v_mfma_f32_32x32x16_bf16 v[96:111], v[36:39], v[24:27], v[96:111]
    ds_read_b64_tr_b16 v[56:57], v21 offset:26624
    ds_read_b64_tr_b16 v[58:59], v21 offset:27136
    v_mfma_f32_32x32x16_bf16 v[112:127], v[36:39], v[28:31], v[112:127]
    ds_read_b64_tr_b16 v[60:61], v21 offset:34816
    ds_read_b64_tr_b16 v[62:63], v21 offset:35328
    v_mfma_f32_32x32x16_bf16 v[128:143], v[24:27], v[40:43], v[128:143]
    v_mfma_f32_32x32x16_bf16 v[144:159], v[28:31], v[40:43], v[144:159]
    s_waitcnt lgkmcnt(0)
    v_mfma_f32_32x32x16_bf16 v[64:79], v[52:55], v[44:47], v[64:79]
    ds_read_b128 v[24:27], v14 offset:0
    ds_read_b128 v[28:31], v14 offset:4096
    v_mfma_f32_32x32x16_bf16 v[80:95], v[52:55], v[48:51], v[80:95]
    ds_read_b64_tr_b16 v[32:33], v21 offset:20480
    ds_read_b64_tr_b16 v[34:35], v21 offset:20992
    v_mfma_f32_32x32x16_bf16 v[96:111], v[56:59], v[44:47], v[96:111]
    ds_read_b64_tr_b16 v[36:37], v21 offset:28672
    ds_read_b64_tr_b16 v[38:39], v21 offset:29184
    v_mfma_f32_32x32x16_bf16 v[112:127], v[56:59], v[48:51], v[112:127]
    ds_read_b64_tr_b16 v[40:41], v21 offset:36864
    ds_read_b64_tr_b16 v[42:43], v21 offset:37376
    v_mfma_f32_32x32x16_bf16 v[128:143], v[44:47], v[60:63], v[128:143]
    v_mfma_f32_32x32x16_bf16 v[144:159], v[48:51], v[60:63], v[144:159]
    s_waitcnt lgkmcnt(0)
    v_mfma_f32_32x32x16_bf16 v[64:79], v[32:35], v[24:27], v[64:79]
    ds_read_b128 v[44:47], v15 offset:0
    ds_read_b128 v[48:51], v15 offset:4096
    v_mfma_f32_32x32x16_bf16 v[80:95], v[32:35], v[28:31], v[80:95]
    ds_read_b64_tr_b16 v[52:53], v21 offset:22528
    ds_read_b64_tr_b16 v[54:55], v21 offset:23040
    v_mfma_f32_32x32x16_bf16 v[96:111], v[36:39], v[24:27], v[96:111]
    ds_read_b64_tr_b16 v[56:57], v21 offset:30720
    ds_read_b64_tr_b16 v[58:59], v21 offset:31232
    v_mfma_f32_32x32x16_bf16 v[112:127], v[36:39], v[28:31], v[112:127]
    ds_read_b64_tr_b16 v[60:61], v21 offset:38912
    ds_read_b64_tr_b16 v[62:63], v21 offset:39424
    v_mfma_f32_32x32x16_bf16 v[128:143], v[24:27], v[40:43], v[128:143]
    v_mfma_f32_32x32x16_bf16 v[144:159], v[28:31], v[40:43], v[144:159]
    s_waitcnt lgkmcnt(0)
    s_barrier
    v_mfma_f32_32x32x16_bf16 v[64:79], v[52:55], v[44:47], v[64:79]
    ds_read_b128 v[24:27], v16 offset:0
    ds_read_b128 v[28:31], v16 offset:4096
    v_mfma_f32_32x32x16_bf16 v[80:95], v[52:55], v[48:51], v[80:95]
    ds_read_b64_tr_b16 v[32:33], v22 offset:16384
    ds_read_b64_tr_b16 v[34:35], v22 offset:16896
    v_mfma_f32_32x32x16_bf16 v[96:111], v[56:59], v[44:47], v[96:111]
    ds_read_b64_tr_b16 v[36:37], v22 offset:24576
    ds_read_b64_tr_b16 v[38:39], v22 offset:25088
    v_mfma_f32_32x32x16_bf16 v[112:127], v[56:59], v[48:51], v[112:127]
    ds_read_b64_tr_b16 v[40:41], v22 offset:32768
    ds_read_b64_tr_b16 v[42:43], v22 offset:33280
    v_mfma_f32_32x32x16_bf16 v[128:143], v[44:47], v[60:63], v[128:143]
    v_mfma_f32_32x32x16_bf16 v[144:159], v[48:51], v[60:63], v[144:159]
    s_waitcnt lgkmcnt(0)
    v_mfma_f32_32x32x16_bf16 v[64:79], v[32:35], v[24:27], v[64:79]
    ds_read_b128 v[44:47], v17 offset:0
    ds_read_b128 v[48:51], v17 offset:4096
    v_mfma_f32_32x32x16_bf16 v[80:95], v[32:35], v[28:31], v[80:95]
    ds_read_b64_tr_b16 v[52:53], v22 offset:18432
    ds_read_b64_tr_b16 v[54:55], v22 offset:18944
    v_mfma_f32_32x32x16_bf16 v[96:111], v[36:39], v[24:27], v[96:111]
    ds_read_b64_tr_b16 v[56:57], v22 offset:26624
    ds_read_b64_tr_b16 v[58:59], v22 offset:27136
    v_mfma_f32_32x32x16_bf16 v[112:127], v[36:39], v[28:31], v[112:127]
    ds_read_b64_tr_b16 v[60:61], v22 offset:34816
    ds_read_b64_tr_b16 v[62:63], v22 offset:35328
    v_mfma_f32_32x32x16_bf16 v[128:143], v[24:27], v[40:43], v[128:143]
    v_mfma_f32_32x32x16_bf16 v[144:159], v[28:31], v[40:43], v[144:159]
    s_waitcnt lgkmcnt(0)
    v_mfma_f32_32x32x16_bf16 v[64:79], v[52:55], v[44:47], v[64:79]
    ds_read_b128 v[24:27], v18 offset:0
    ds_read_b128 v[28:31], v18 offset:4096
    v_mfma_f32_32x32x16_bf16 v[80:95], v[52:55], v[48:51], v[80:95]
    ds_read_b64_tr_b16 v[32:33], v22 offset:20480
    ds_read_b64_tr_b16 v[34:35], v22 offset:20992
    v_mfma_f32_32x32x16_bf16 v[96:111], v[56:59], v[44:47], v[96:111]
    ds_read_b64_tr_b16 v[36:37], v22 offset:28672
    ds_read_b64_tr_b16 v[38:39], v22 offset:29184
    v_mfma_f32_32x32x16_bf16 v[112:127], v[56:59], v[48:51], v[112:127]
    ds_read_b64_tr_b16 v[40:41], v22 offset:36864
    ds_read_b64_tr_b16 v[42:43], v22 offset:37376
    v_mfma_f32_32x32x16_bf16 v[128:143], v[44:47], v[60:63], v[128:143]
    v_mfma_f32_32x32x16_bf16 v[144:159], v[48:51], v[60:63], v[144:159]
    s_waitcnt lgkmcnt(0)
    v_mfma_f32_32x32x16_bf16 v[64:79], v[32:35], v[24:27], v[64:79]
    ds_read_b128 v[44:47], v19 offset:0
    ds_read_b128 v[48:51], v19 offset:4096
    v_mfma_f32_32x32x16_bf16 v[80:95], v[32:35], v[28:31], v[80:95]
    ds_read_b64_tr_b16 v[52:53], v22 offset:22528
    ds_read_b64_tr_b16 v[54:55], v22 offset:23040
    v_mfma_f32_32x32x16_bf16 v[96:111], v[36:39], v[24:27], v[96:111]
    ds_read_b64_tr_b16 v[56:57], v22 offset:30720
    ds_read_b64_tr_b16 v[58:59], v22 offset:31232
    v_mfma_f32_32x32x16_bf16 v[112:127], v[36:39], v[28:31], v[112:127]
    ds_read_b64_tr_b16 v[60:61], v22 offset:38912
    ds_read_b64_tr_b16 v[62:63], v22 offset:39424
    v_mfma_f32_32x32x16_bf16 v[128:143], v[24:27], v[40:43], v[128:143]
    v_mfma_f32_32x32x16_bf16 v[144:159], v[28:31], v[40:43], v[144:159]
    s_waitcnt lgkmcnt(0)
    s_barrier
    v_mfma_f32_32x32x16_bf16 v[64:79], v[52:55], v[44:47], v[64:79]
    ds_read_b128 v[24:27], v8 offset:0
    ds_read_b128 v[28:31], v8 offset:4096
    v_mfma_f32_32x32x16_bf16 v[80:95], v[52:55], v[48:51], v[80:95]
    ds_read_b64_tr_b16 v[32:33], v20 offset:16384
    ds_read_b64_tr_b16 v[34:35], v20 offset:16896
    v_mfma_f32_32x32x16_bf16 v[96:111], v[56:59], v[44:47], v[96:111]
    ds_read_b64_tr_b16 v[36:37], v20 offset:24576
    ds_read_b64_tr_b16 v[38:39], v20 offset:25088
    v_mfma_f32_32x32x16_bf16 v[112:127], v[56:59], v[48:51], v[112:127]
    ds_read_b64_tr_b16 v[40:41], v20 offset:32768
    ds_read_b64_tr_b16 v[42:43], v20 offset:33280
    v_mfma_f32_32x32x16_bf16 v[128:143], v[44:47], v[60:63], v[128:143]
    v_mfma_f32_32x32x16_bf16 v[144:159], v[48:51], v[60:63], v[144:159]
    s_waitcnt lgkmcnt(0)
    v_mfma_f32_32x32x16_bf16 v[64:79], v[32:35], v[24:27], v[64:79]
    ds_read_b128 v[44:47], v9 offset:0
    ds_read_b128 v[48:51], v9 offset:4096
    v_mfma_f32_32x32x16_bf16 v[80:95], v[32:35], v[28:31], v[80:95]
    ds_read_b64_tr_b16 v[52:53], v20 offset:18432
    ds_read_b64_tr_b16 v[54:55], v20 offset:18944
    v_mfma_f32_32x32x16_bf16 v[96:111], v[36:39], v[24:27], v[96:111]
    ds_read_b64_tr_b16 v[56:57], v20 offset:26624
    ds_read_b64_tr_b16 v[58:59], v20 offset:27136
    v_mfma_f32_32x32x16_bf16 v[112:127], v[36:39], v[28:31], v[112:127]
    ds_read_b64_tr_b16 v[60:61], v20 offset:34816
    ds_read_b64_tr_b16 v[62:63], v20 offset:35328
    v_mfma_f32_32x32x16_bf16 v[128:143], v[24:27], v[40:43], v[128:143]
    v_mfma_f32_32x32x16_bf16 v[144:159], v[28:31], v[40:43], v[144:159]
    s_waitcnt lgkmcnt(0)
    v_mfma_f32_32x32x16_bf16 v[64:79], v[52:55], v[44:47], v[64:79]
    ds_read_b128 v[24:27], v10 offset:0
    ds_read_b128 v[28:31], v10 offset:4096
    v_mfma_f32_32x32x16_bf16 v[80:95], v[52:55], v[48:51], v[80:95]
    ds_read_b64_tr_b16 v[32:33], v20 offset:20480
    ds_read_b64_tr_b16 v[34:35], v20 offset:20992
    v_mfma_f32_32x32x16_bf16 v[96:111], v[56:59], v[44:47], v[96:111]
    ds_read_b64_tr_b16 v[36:37], v20 offset:28672
    ds_read_b64_tr_b16 v[38:39], v20 offset:29184
    v_mfma_f32_32x32x16_bf16 v[112:127], v[56:59], v[48:51], v[112:127]
    ds_read_b64_tr_b16 v[40:41], v20 offset:36864
    ds_read_b64_tr_b16 v[42:43], v20 offset:37376
    v_mfma_f32_32x32x16_bf16 v[128:143], v[44:47], v[60:63], v[128:143]
    v_mfma_f32_32x32x16_bf16 v[144:159], v[48:51], v[60:63], v[144:159]
    s_waitcnt lgkmcnt(0)
    v_mfma_f32_32x32x16_bf16 v[64:79], v[32:35], v[24:27], v[64:79]
    ds_read_b128 v[44:47], v11 offset:0
    ds_read_b128 v[48:51], v11 offset:4096
    v_mfma_f32_32x32x16_bf16 v[80:95], v[32:35], v[28:31], v[80:95]
    ds_read_b64_tr_b16 v[52:53], v20 offset:22528
    ds_read_b64_tr_b16 v[54:55], v20 offset:23040
    v_mfma_f32_32x32x16_bf16 v[96:111], v[36:39], v[24:27], v[96:111]
    ds_read_b64_tr_b16 v[56:57], v20 offset:30720
    ds_read_b64_tr_b16 v[58:59], v20 offset:31232
    v_mfma_f32_32x32x16_bf16 v[112:127], v[36:39], v[28:31], v[112:127]
    ds_read_b64_tr_b16 v[60:61], v20 offset:38912
    ds_read_b64_tr_b16 v[62:63], v20 offset:39424
    v_mfma_f32_32x32x16_bf16 v[128:143], v[24:27], v[40:43], v[128:143]
    v_mfma_f32_32x32x16_bf16 v[144:159], v[28:31], v[40:43], v[144:159]
    s_waitcnt lgkmcnt(0)
    s_barrier
    v_mfma_f32_32x32x16_bf16 v[64:79], v[52:55], v[44:47], v[64:79]
    ds_read_b128 v[24:27], v12 offset:0
    ds_read_b128 v[28:31], v12 offset:4096
    v_mfma_f32_32x32x16_bf16 v[80:95], v[52:55], v[48:51], v[80:95]
    ds_read_b64_tr_b16 v[32:33], v21 offset:16384
    ds_read_b64_tr_b16 v[34:35], v21 offset:16896
    v_mfma_f32_32x32x16_bf16 v[96:111], v[56:59], v[44:47], v[96:111]
    ds_read_b64_tr_b16 v[36:37], v21 offset:24576
    ds_read_b64_tr_b16 v[38:39], v21 offset:25088
    v_mfma_f32_32x32x16_bf16 v[112:127], v[56:59], v[48:51], v[112:127]
    ds_read_b64_tr_b16 v[40:41], v21 offset:32768
    ds_read_b64_tr_b16 v[42:43], v21 offset:33280
    v_mfma_f32_32x32x16_bf16 v[128:143], v[44:47], v[60:63], v[128:143]
    v_mfma_f32_32x32x16_bf16 v[144:159], v[48:51], v[60:63], v[144:159]
    s_waitcnt lgkmcnt(0)
    v_mfma_f32_32x32x16_bf16 v[64:79], v[32:35], v[24:27], v[64:79]
    ds_read_b128 v[44:47], v13 offset:0
    ds_read_b128 v[48:51], v13 offset:4096
    v_mfma_f32_32x32x16_bf16 v[80:95], v[32:35], v[28:31], v[80:95]
    ds_read_b64_tr_b16 v[52:53], v21 offset:18432
    ds_read_b64_tr_b16 v[54:55], v21 offset:18944
    v_mfma_f32_32x32x16_bf16 v[96:111], v[36:39], v[24:27], v[96:111]
    ds_read_b64_tr_b16 v[56:57], v21 offset:26624
    ds_read_b64_tr_b16 v[58:59], v21 offset:27136
    v_mfma_f32_32x32x16_bf16 v[112:127], v[36:39], v[28:31], v[112:127]
    ds_read_b64_tr_b16 v[60:61], v21 offset:34816
    ds_read_b64_tr_b16 v[62:63], v21 offset:35328
    v_mfma_f32_32x32x16_bf16 v[128:143], v[24:27], v[40:43], v[128:143]
    v_mfma_f32_32x32x16_bf16 v[144:159], v[28:31], v[40:43], v[144:159]
    s_waitcnt lgkmcnt(0)
    v_mfma_f32_32x32x16_bf16 v[64:79], v[52:55], v[44:47], v[64:79]
    ds_read_b128 v[24:27], v14 offset:0
    ds_read_b128 v[28:31], v14 offset:4096
    v_mfma_f32_32x32x16_bf16 v[80:95], v[52:55], v[48:51], v[80:95]
    ds_read_b64_tr_b16 v[32:33], v21 offset:20480
    ds_read_b64_tr_b16 v[34:35], v21 offset:20992
    v_mfma_f32_32x32x16_bf16 v[96:111], v[56:59], v[44:47], v[96:111]
    ds_read_b64_tr_b16 v[36:37], v21 offset:28672
    ds_read_b64_tr_b16 v[38:39], v21 offset:29184
    v_mfma_f32_32x32x16_bf16 v[112:127], v[56:59], v[48:51], v[112:127]
    ds_read_b64_tr_b16 v[40:41], v21 offset:36864
    ds_read_b64_tr_b16 v[42:43], v21 offset:37376
    v_mfma_f32_32x32x16_bf16 v[128:143], v[44:47], v[60:63], v[128:143]
    v_mfma_f32_32x32x16_bf16 v[144:159], v[48:51], v[60:63], v[144:159]
    s_waitcnt lgkmcnt(0)
    v_mfma_f32_32x32x16_bf16 v[64:79], v[32:35], v[24:27], v[64:79]
    ds_read_b128 v[44:47], v15 offset:0
    ds_read_b128 v[48:51], v15 offset:4096
    v_mfma_f32_32x32x16_bf16 v[80:95], v[32:35], v[28:31], v[80:95]
    ds_read_b64_tr_b16 v[52:53], v21 offset:22528
    ds_read_b64_tr_b16 v[54:55], v21 offset:23040
    v_mfma_f32_32x32x16_bf16 v[96:111], v[36:39], v[24:27], v[96:111]
    ds_read_b64_tr_b16 v[56:57], v21 offset:30720
    ds_read_b64_tr_b16 v[58:59], v21 offset:31232
    v_mfma_f32_32x32x16_bf16 v[112:127], v[36:39], v[28:31], v[112:127]
    ds_read_b64_tr_b16 v[60:61], v21 offset:38912
    ds_read_b64_tr_b16 v[62:63], v21 offset:39424
    v_mfma_f32_32x32x16_bf16 v[128:143], v[24:27], v[40:43], v[128:143]
    v_mfma_f32_32x32x16_bf16 v[144:159], v[28:31], v[40:43], v[144:159]
    s_waitcnt lgkmcnt(0)
    s_barrier
    v_mfma_f32_32x32x16_bf16 v[64:79], v[52:55], v[44:47], v[64:79]
    ds_read_b128 v[24:27], v16 offset:0
    ds_read_b128 v[28:31], v16 offset:4096
    v_mfma_f32_32x32x16_bf16 v[80:95], v[52:55], v[48:51], v[80:95]
    ds_read_b64_tr_b16 v[32:33], v22 offset:16384
    ds_read_b64_tr_b16 v[34:35], v22 offset:16896
    v_mfma_f32_32x32x16_bf16 v[96:111], v[56:59], v[44:47], v[96:111]
    ds_read_b64_tr_b16 v[36:37], v22 offset:24576
    ds_read_b64_tr_b16 v[38:39], v22 offset:25088
    v_mfma_f32_32x32x16_bf16 v[112:127], v[56:59], v[48:51], v[112:127]
    ds_read_b64_tr_b16 v[40:41], v22 offset:32768
    ds_read_b64_tr_b16 v[42:43], v22 offset:33280
    v_mfma_f32_32x32x16_bf16 v[128:143], v[44:47], v[60:63], v[128:143]
    v_mfma_f32_32x32x16_bf16 v[144:159], v[48:51], v[60:63], v[144:159]
    s_waitcnt lgkmcnt(0)
    v_mfma_f32_32x32x16_bf16 v[64:79], v[32:35], v[24:27], v[64:79]
    ds_read_b128 v[44:47], v17 offset:0
    ds_read_b128 v[48:51], v17 offset:4096
    v_mfma_f32_32x32x16_bf16 v[80:95], v[32:35], v[28:31], v[80:95]
    ds_read_b64_tr_b16 v[52:53], v22 offset:18432
    ds_read_b64_tr_b16 v[54:55], v22 offset:18944
    v_mfma_f32_32x32x16_bf16 v[96:111], v[36:39], v[24:27], v[96:111]
    ds_read_b64_tr_b16 v[56:57], v22 offset:26624
    ds_read_b64_tr_b16 v[58:59], v22 offset:27136
    v_mfma_f32_32x32x16_bf16 v[112:127], v[36:39], v[28:31], v[112:127]
    ds_read_b64_tr_b16 v[60:61], v22 offset:34816
    ds_read_b64_tr_b16 v[62:63], v22 offset:35328
    v_mfma_f32_32x32x16_bf16 v[128:143], v[24:27], v[40:43], v[128:143]
    v_mfma_f32_32x32x16_bf16 v[144:159], v[28:31], v[40:43], v[144:159]
    s_waitcnt lgkmcnt(0)
    v_mfma_f32_32x32x16_bf16 v[64:79], v[52:55], v[44:47], v[64:79]
    ds_read_b128 v[24:27], v18 offset:0
    ds_read_b128 v[28:31], v18 offset:4096
    v_mfma_f32_32x32x16_bf16 v[80:95], v[52:55], v[48:51], v[80:95]
    ds_read_b64_tr_b16 v[32:33], v22 offset:20480
    ds_read_b64_tr_b16 v[34:35], v22 offset:20992
    v_mfma_f32_32x32x16_bf16 v[96:111], v[56:59], v[44:47], v[96:111]
    ds_read_b64_tr_b16 v[36:37], v22 offset:28672
    ds_read_b64_tr_b16 v[38:39], v22 offset:29184
    v_mfma_f32_32x32x16_bf16 v[112:127], v[56:59], v[48:51], v[112:127]
    ds_read_b64_tr_b16 v[40:41], v22 offset:36864
    ds_read_b64_tr_b16 v[42:43], v22 offset:37376
    v_mfma_f32_32x32x16_bf16 v[128:143], v[44:47], v[60:63], v[128:143]
    v_mfma_f32_32x32x16_bf16 v[144:159], v[48:51], v[60:63], v[144:159]
    s_waitcnt lgkmcnt(0)
    v_mfma_f32_32x32x16_bf16 v[64:79], v[32:35], v[24:27], v[64:79]
    ds_read_b128 v[44:47], v19 offset:0
    ds_read_b128 v[48:51], v19 offset:4096
    v_mfma_f32_32x32x16_bf16 v[80:95], v[32:35], v[28:31], v[80:95]
    ds_read_b64_tr_b16 v[52:53], v22 offset:22528
    ds_read_b64_tr_b16 v[54:55], v22 offset:23040
    v_mfma_f32_32x32x16_bf16 v[96:111], v[36:39], v[24:27], v[96:111]
    ds_read_b64_tr_b16 v[56:57], v22 offset:30720
    ds_read_b64_tr_b16 v[58:59], v22 offset:31232
    v_mfma_f32_32x32x16_bf16 v[112:127], v[36:39], v[28:31], v[112:127]
    ds_read_b64_tr_b16 v[60:61], v22 offset:38912
    ds_read_b64_tr_b16 v[62:63], v22 offset:39424
    v_mfma_f32_32x32x16_bf16 v[128:143], v[24:27], v[40:43], v[128:143]
    v_mfma_f32_32x32x16_bf16 v[144:159], v[28:31], v[40:43], v[144:159]
    s_waitcnt lgkmcnt(0)
    s_barrier
    v_mfma_f32_32x32x16_bf16 v[64:79], v[52:55], v[44:47], v[64:79]
    ds_read_b128 v[24:27], v8 offset:0
    ds_read_b128 v[28:31], v8 offset:4096
    v_mfma_f32_32x32x16_bf16 v[80:95], v[52:55], v[48:51], v[80:95]
    ds_read_b64_tr_b16 v[32:33], v20 offset:16384
    ds_read_b64_tr_b16 v[34:35], v20 offset:16896
    v_mfma_f32_32x32x16_bf16 v[96:111], v[56:59], v[44:47], v[96:111]
    ds_read_b64_tr_b16 v[36:37], v20 offset:24576
    ds_read_b64_tr_b16 v[38:39], v20 offset:25088
    v_mfma_f32_32x32x16_bf16 v[112:127], v[56:59], v[48:51], v[112:127]
    ds_read_b64_tr_b16 v[40:41], v20 offset:32768
    ds_read_b64_tr_b16 v[42:43], v20 offset:33280
    v_mfma_f32_32x32x16_bf16 v[128:143], v[44:47], v[60:63], v[128:143]
    v_mfma_f32_32x32x16_bf16 v[144:159], v[48:51], v[60:63], v[144:159]
    s_waitcnt lgkmcnt(0)
    v_mfma_f32_32x32x16_bf16 v[64:79], v[32:35], v[24:27], v[64:79]
    ds_read_b128 v[44:47], v9 offset:0
    ds_read_b128 v[48:51], v9 offset:4096
    v_mfma_f32_32x32x16_bf16 v[80:95], v[32:35], v[28:31], v[80:95]
    ds_read_b64_tr_b16 v[52:53], v20 offset:18432
    ds_read_b64_tr_b16 v[54:55], v20 offset:18944
    v_mfma_f32_32x32x16_bf16 v[96:111], v[36:39], v[24:27], v[96:111]
    ds_read_b64_tr_b16 v[56:57], v20 offset:26624
    ds_read_b64_tr_b16 v[58:59], v20 offset:27136
    v_mfma_f32_32x32x16_bf16 v[112:127], v[36:39], v[28:31], v[112:127]
    ds_read_b64_tr_b16 v[60:61], v20 offset:34816
    ds_read_b64_tr_b16 v[62:63], v20 offset:35328
    v_mfma_f32_32x32x16_bf16 v[128:143], v[24:27], v[40:43], v[128:143]
    v_mfma_f32_32x32x16_bf16 v[144:159], v[28:31], v[40:43], v[144:159]
    s_waitcnt lgkmcnt(0)
    v_mfma_f32_32x32x16_bf16 v[64:79], v[52:55], v[44:47], v[64:79]
    ds_read_b128 v[24:27], v10 offset:0
    ds_read_b128 v[28:31], v10 offset:4096
    v_mfma_f32_32x32x16_bf16 v[80:95], v[52:55], v[48:51], v[80:95]
    ds_read_b64_tr_b16 v[32:33], v20 offset:20480
    ds_read_b64_tr_b16 v[34:35], v20 offset:20992
    v_mfma_f32_32x32x16_bf16 v[96:111], v[56:59], v[44:47], v[96:111]
    ds_read_b64_tr_b16 v[36:37], v20 offset:28672
    ds_read_b64_tr_b16 v[38:39], v20 offset:29184
    v_mfma_f32_32x32x16_bf16 v[112:127], v[56:59], v[48:51], v[112:127]
    ds_read_b64_tr_b16 v[40:41], v20 offset:36864
    ds_read_b64_tr_b16 v[42:43], v20 offset:37376
    v_mfma_f32_32x32x16_bf16 v[128:143], v[44:47], v[60:63], v[128:143]
    v_mfma_f32_32x32x16_bf16 v[144:159], v[48:51], v[60:63], v[144:159]
    s_waitcnt lgkmcnt(0)
    v_mfma_f32_32x32x16_bf16 v[64:79], v[32:35], v[24:27], v[64:79]
    ds_read_b128 v[44:47], v11 offset:0
    ds_read_b128 v[48:51], v11 offset:4096
    v_mfma_f32_32x32x16_bf16 v[80:95], v[32:35], v[28:31], v[80:95]
    ds_read_b64_tr_b16 v[52:53], v20 offset:22528
    ds_read_b64_tr_b16 v[54:55], v20 offset:23040
    v_mfma_f32_32x32x16_bf16 v[96:111], v[36:39], v[24:27], v[96:111]
    ds_read_b64_tr_b16 v[56:57], v20 offset:30720
    ds_read_b64_tr_b16 v[58:59], v20 offset:31232
    v_mfma_f32_32x32x16_bf16 v[112:127], v[36:39], v[28:31], v[112:127]
    ds_read_b64_tr_b16 v[60:61], v20 offset:38912
    ds_read_b64_tr_b16 v[62:63], v20 offset:39424
    v_mfma_f32_32x32x16_bf16 v[128:143], v[24:27], v[40:43], v[128:143]
    v_mfma_f32_32x32x16_bf16 v[144:159], v[28:31], v[40:43], v[144:159]
    s_waitcnt lgkmcnt(0)
    v_mfma_f32_32x32x16_bf16 v[64:79], v[52:55], v[44:47], v[64:79]
    v_mfma_f32_32x32x16_bf16 v[80:95], v[52:55], v[48:51], v[80:95]
    v_mfma_f32_32x32x16_bf16 v[96:111], v[56:59], v[44:47], v[96:111]
    v_mfma_f32_32x32x16_bf16 v[112:127], v[56:59], v[48:51], v[112:127]
    v_mfma_f32_32x32x16_bf16 v[128:143], v[44:47], v[60:63], v[128:143]
    v_mfma_f32_32x32x16_bf16 v[144:159], v[48:51], v[60:63], v[144:159]
    v_lshlrev_b32 v53, 4, v0
    s_mul_i32 s38, s3, 6144
    s_add_u32 s38, s38, 126976
    v_add_u32 v54, s38, v53
    s_nop 7
    v_cvt_pk_bf16_f32 v112, v112, v113
    v_cvt_pk_bf16_f32 v113, v114, v115
    v_cvt_pk_bf16_f32 v114, v116, v117
    v_cvt_pk_bf16_f32 v115, v118, v119
    v_cvt_pk_bf16_f32 v116, v120, v121
    v_cvt_pk_bf16_f32 v117, v122, v123
    v_cvt_pk_bf16_f32 v118, v124, v125
    v_cvt_pk_bf16_f32 v119, v126, v127
    v_cvt_pk_bf16_f32 v144, v144, v145
    v_cvt_pk_bf16_f32 v145, v146, v147
    v_cvt_pk_bf16_f32 v146, v148, v149
    v_cvt_pk_bf16_f32 v147, v150, v151
    v_cvt_pk_bf16_f32 v148, v152, v153
    v_cvt_pk_bf16_f32 v149, v154, v155
    v_cvt_pk_bf16_f32 v150, v156, v157
    v_cvt_pk_bf16_f32 v151, v158, v159
    v_cvt_pk_bf16_f32 v80, v80, v81
    v_cvt_pk_bf16_f32 v81, v82, v83
    v_cvt_pk_bf16_f32 v82, v84, v85
    v_cvt_pk_bf16_f32 v83, v86, v87
    v_cvt_pk_bf16_f32 v84, v88, v89
    v_cvt_pk_bf16_f32 v85, v90, v91
    v_cvt_pk_bf16_f32 v86, v92, v93
    v_cvt_pk_bf16_f32 v87, v94, v95
    ds_write_b128 v54, v[112:115] offset:0
    ds_write_b128 v54, v[116:119] offset:1024
    ds_write_b128 v54, v[144:147] offset:2048
    ds_write_b128 v54, v[148:151] offset:3072
    ds_write_b128 v54, v[80:83] offset:4096
    ds_write_b128 v54, v[84:87] offset:5120
    v_cvt_pk_bf16_f32 v96, v96, v97
    v_cvt_pk_bf16_f32 v97, v98, v99
    v_cvt_pk_bf16_f32 v98, v100, v101
    v_cvt_pk_bf16_f32 v99, v102, v103
    v_cvt_pk_bf16_f32 v100, v104, v105
    v_cvt_pk_bf16_f32 v101, v106, v107
    v_cvt_pk_bf16_f32 v102, v108, v109
    v_cvt_pk_bf16_f32 v103, v110, v111
    v_cvt_pk_bf16_f32 v128, v128, v129
    v_cvt_pk_bf16_f32 v129, v130, v131
    v_cvt_pk_bf16_f32 v130, v132, v133
    v_cvt_pk_bf16_f32 v131, v134, v135
    v_cvt_pk_bf16_f32 v132, v136, v137
    v_cvt_pk_bf16_f32 v133, v138, v139
    v_cvt_pk_bf16_f32 v134, v140, v141
    v_cvt_pk_bf16_f32 v135, v142, v143
    v_cvt_pk_bf16_f32 v64, v64, v65
    v_cvt_pk_bf16_f32 v65, v66, v67
    v_cvt_pk_bf16_f32 v66, v68, v69
    v_cvt_pk_bf16_f32 v67, v70, v71
    v_cvt_pk_bf16_f32 v68, v72, v73
    v_cvt_pk_bf16_f32 v69, v74, v75
    v_cvt_pk_bf16_f32 v70, v76, v77
    v_cvt_pk_bf16_f32 v71, v78, v79
    s_waitcnt vmcnt(0) lgkmcnt(0)
    s_barrier
    s_branch Lp1_epi
Lp1_loader:
    v_lshrrev_b32 v5, 3, v0
    v_and_b32 v6, 7, v0
    v_lshrrev_b32 v7, 4, v0
    v_xor_b32 v2, v6, v7
    v_xor_b32 v3, 4, v2
    v_lshlrev_b32 v2, 4, v2
    v_lshl_add_u32 v2, v5, 11, v2
    v_lshlrev_b32 v3, 4, v3
    v_lshl_add_u32 v3, v5, 11, v3
    v_and_b32 v7, 2, v5
    v_lshlrev_b32 v7, 1, v7
    v_xor_b32 v4, v6, v7
    v_lshlrev_b32 v4, 4, v4
    s_mov_b32 s42, 6144
    v_mul_lo_u32 v7, v5, s42
    v_add_u32 v4, v4, v7
    s_and_b32 s45, s3, 3
    s_mul_i32 s42, s45, 65536
    s_add_u32 s44, s36, s42
    s_mul_i32 s52, s45, 4096
    s_mul_i32 s53, s45, 6144
    s_mul_i32 s42, s45, 6
    s_add_u32 s42, s42, 0
    s_lshr_b32 s43, s42, 3
    s_and_b32 s42, s42, 7
    s_lshl_b32 s43, s43, 11
    s_mul_i32 s42, s42, 49152
    s_add_u32 s46, s42, s43
    s_add_u32 s46, s46, s37
    s_mul_i32 s42, s45, 6
    s_add_u32 s42, s42, 1
    s_lshr_b32 s43, s42, 3
    s_and_b32 s42, s42, 7
    s_lshl_b32 s43, s43, 11
    s_mul_i32 s42, s42, 49152
    s_add_u32 s47, s42, s43
    s_add_u32 s47, s47, s37
    s_mul_i32 s42, s45, 6
    s_add_u32 s42, s42, 2
    s_lshr_b32 s43, s42, 3
    s_and_b32 s42, s42, 7
    s_lshl_b32 s43, s43, 11
    s_mul_i32 s42, s42, 49152
    s_add_u32 s48, s42, s43
    s_add_u32 s48, s48, s37
    s_mul_i32 s42, s45, 6
    s_add_u32 s42, s42, 3
    s_lshr_b32 s43, s42, 3
    s_and_b32 s42, s42, 7
    s_lshl_b32 s43, s43, 11
    s_mul_i32 s42, s42, 49152
    s_add_u32 s49, s42, s43
    s_add_u32 s49, s49, s37
    s_mul_i32 s42, s45, 6
    s_add_u32 s42, s42, 4
    s_lshr_b32 s43, s42, 3
    s_and_b32 s42, s42, 7
    s_lshl_b32 s43, s43, 11
    s_mul_i32 s42, s42, 49152
    s_add_u32 s50, s42, s43
    s_add_u32 s50, s50, s37
    s_mul_i32 s42, s45, 6
    s_add_u32 s42, s42, 5
    s_lshr_b32 s43, s42, 3
    s_and_b32 s42, s42, 7
    s_lshl_b32 s43, s43, 11
    s_mul_i32 s42, s42, 49152
    s_add_u32 s51, s42, s43
    s_add_u32 s51, s51, s37
    s_add_u32 m0, s52, 0
    s_add_u32 s43, s44, 0
    buffer_load_dwordx4 v2, s[12:15], s43 offen lds
    s_add_u32 m0, s52, 1024
    s_add_u32 s43, s44, 16384
    buffer_load_dwordx4 v3, s[12:15], s43 offen lds
    s_add_u32 m0, s52, 2048
    s_add_u32 s43, s44, 32768
    buffer_load_dwordx4 v2, s[12:15], s43 offen lds
    s_add_u32 m0, s52, 3072
    s_add_u32 s43, s44, 49152
    buffer_load_dwordx4 v3, s[12:15], s43 offen lds
    s_add_u32 m0, s53, 16384
    s_add_u32 s43, s46, 0
    buffer_load_dwordx4 v4, s[16:19], s43 offen lds
    s_add_u32 m0, s53, 17408
    s_add_u32 s43, s47, 0
    buffer_load_dwordx4 v4, s[16:19], s43 offen lds
    s_add_u32 m0, s53, 18432
    s_add_u32 s43, s48, 0
    buffer_load_dwordx4 v4, s[16:19], s43 offen lds
    s_add_u32 m0, s53, 19456
    s_add_u32 s43, s49, 0
    buffer_load_dwordx4 v4, s[16:19], s43 offen lds
    s_add_u32 m0, s53, 20480
    s_add_u32 s43, s50, 0
    buffer_load_dwordx4 v4, s[16:19], s43 offen lds
    s_add_u32 m0, s53, 21504
    s_add_u32 s43, s51, 0
    buffer_load_dwordx4 v4, s[16:19], s43 offen lds
    s_add_u32 m0, s52, 40960
    s_add_u32 s43, s44, 128
    buffer_load_dwordx4 v2, s[12:15], s43 offen lds
    s_add_u32 m0, s52, 41984
    s_add_u32 s43, s44, 16512
    buffer_load_dwordx4 v3, s[12:15], s43 offen lds
    s_add_u32 m0, s52, 43008
    s_add_u32 s43, s44, 32896
    buffer_load_dwordx4 v2, s[12:15], s43 offen lds
    s_add_u32 m0, s52, 44032
    s_add_u32 s43, s44, 49280
    buffer_load_dwordx4 v3, s[12:15], s43 offen lds
    s_add_u32 m0, s53, 57344
    s_add_u32 s43, s46, 393216
    buffer_load_dwordx4 v4, s[16:19], s43 offen lds
    s_add_u32 m0, s53, 58368
    s_add_u32 s43, s47, 393216
    buffer_load_dwordx4 v4, s[16:19], s43 offen lds
    s_add_u32 m0, s53, 59392
    s_add_u32 s43, s48, 393216
    buffer_load_dwordx4 v4, s[16:19], s43 offen lds
    s_add_u32 m0, s53, 60416
    s_add_u32 s43, s49, 393216
    buffer_load_dwordx4 v4, s[16:19], s43 offen lds
    s_add_u32 m0, s53, 61440
    s_add_u32 s43, s50, 393216
    buffer_load_dwordx4 v4, s[16:19], s43 offen lds
    s_add_u32 m0, s53, 62464
    s_add_u32 s43, s51, 393216
    buffer_load_dwordx4 v4, s[16:19], s43 offen lds
    s_waitcnt vmcnt(10)
    s_barrier
    s_add_u32 m0, s52, 81920
    s_add_u32 s43, s44, 256
    buffer_load_dwordx4 v2, s[12:15], s43 offen lds
    s_add_u32 m0, s52, 82944
    s_add_u32 s43, s44, 16640
    buffer_load_dwordx4 v3, s[12:15], s43 offen lds
    s_add_u32 m0, s52, 83968
    s_add_u32 s43, s44, 33024
    buffer_load_dwordx4 v2, s[12:15], s43 offen lds
    s_add_u32 m0, s52, 84992
    s_add_u32 s43, s44, 49408
    buffer_load_dwordx4 v3, s[12:15], s43 offen lds
    s_add_u32 m0, s53, 98304
    s_add_u32 s43, s46, 786432
    buffer_load_dwordx4 v4, s[16:19], s43 offen lds
    s_add_u32 m0, s53, 99328
    s_add_u32 s43, s47, 786432
    buffer_load_dwordx4 v4, s[16:19], s43 offen lds
    s_add_u32 m0, s53, 100352
    s_add_u32 s43, s48, 786432
    buffer_load_dwordx4 v4, s[16:19], s43 offen lds
    s_add_u32 m0, s53, 101376
    s_add_u32 s43, s49, 786432
    buffer_load_dwordx4 v4, s[16:19], s43 offen lds
    s_add_u32 m0, s53, 102400
    s_add_u32 s43, s50, 786432
    buffer_load_dwordx4 v4, s[16:19], s43 offen lds
    s_add_u32 m0, s53, 103424
    s_add_u32 s43, s51, 786432
    buffer_load_dwordx4 v4, s[16:19], s43 offen lds
    s_waitcnt vmcnt(10)
    s_barrier
    s_add_u32 m0, s52, 0
    s_add_u32 s43, s44, 384
    buffer_load_dwordx4 v2, s[12:15], s43 offen lds
    s_add_u32 m0, s52, 1024
    s_add_u32 s43, s44, 16768
    buffer_load_dwordx4 v3, s[12:15], s43 offen lds
    s_add_u32 m0, s52, 2048
    s_add_u32 s43, s44, 33152
    buffer_load_dwordx4 v2, s[12:15], s43 offen lds
    s_add_u32 m0, s52, 3072
    s_add_u32 s43, s44, 49536
    buffer_load_dwordx4 v3, s[12:15], s43 offen lds
    s_add_u32 m0, s53, 16384
    s_add_u32 s43, s46, 1179648
    buffer_load_dwordx4 v4, s[16:19], s43 offen lds
    s_add_u32 m0, s53, 17408
    s_add_u32 s43, s47, 1179648
    buffer_load_dwordx4 v4, s[16:19], s43 offen lds
    s_add_u32 m0, s53, 18432
    s_add_u32 s43, s48, 1179648
    buffer_load_dwordx4 v4, s[16:19], s43 offen lds
    s_add_u32 m0, s53, 19456
    s_add_u32 s43, s49, 1179648
    buffer_load_dwordx4 v4, s[16:19], s43 offen lds
    s_add_u32 m0, s53, 20480
    s_add_u32 s43, s50, 1179648
    buffer_load_dwordx4 v4, s[16:19], s43 offen lds
    s_add_u32 m0, s53, 21504
    s_add_u32 s43, s51, 1179648
    buffer_load_dwordx4 v4, s[16:19], s43 offen lds
    s_waitcnt vmcnt(10)
    s_barrier
    s_add_u32 m0, s52, 40960
    s_add_u32 s43, s44, 512
    buffer_load_dwordx4 v2, s[12:15], s43 offen lds
    s_add_u32 m0, s52, 41984
    s_add_u32 s43, s44, 16896
    buffer_load_dwordx4 v3, s[12:15], s43 offen lds
    s_add_u32 m0, s52, 43008
    s_add_u32 s43, s44, 33280
    buffer_load_dwordx4 v2, s[12:15], s43 offen lds
    s_add_u32 m0, s52, 44032
    s_add_u32 s43, s44, 49664
    buffer_load_dwordx4 v3, s[12:15], s43 offen lds
    s_add_u32 m0, s53, 57344
    s_add_u32 s43, s46, 1572864
    buffer_load_dwordx4 v4, s[16:19], s43 offen lds
    s_add_u32 m0, s53, 58368
    s_add_u32 s43, s47, 1572864
    buffer_load_dwordx4 v4, s[16:19], s43 offen lds
    s_add_u32 m0, s53, 59392
    s_add_u32 s43, s48, 1572864
    buffer_load_dwordx4 v4, s[16:19], s43 offen lds
    s_add_u32 m0, s53, 60416
    s_add_u32 s43, s49, 1572864
    buffer_load_dwordx4 v4, s[16:19], s43 offen lds
    s_add_u32 m0, s53, 61440
    s_add_u32 s43, s50, 1572864
    buffer_load_dwordx4 v4, s[16:19], s43 offen lds
    s_add_u32 m0, s53, 62464
    s_add_u32 s43, s51, 1572864
    buffer_load_dwordx4 v4, s[16:19], s43 offen lds
    s_waitcnt vmcnt(10)
    s_barrier
    s_add_u32 m0, s52, 81920
    s_add_u32 s43, s44, 640
    buffer_load_dwordx4 v2, s[12:15], s43 offen lds
    s_add_u32 m0, s52, 82944
    s_add_u32 s43, s44, 17024
    buffer_load_dwordx4 v3, s[12:15], s43 offen lds
    s_add_u32 m0, s52, 83968
    s_add_u32 s43, s44, 33408
    buffer_load_dwordx4 v2, s[12:15], s43 offen lds
    s_add_u32 m0, s52, 84992
    s_add_u32 s43, s44, 49792
    buffer_load_dwordx4 v3, s[12:15], s43 offen lds
    s_add_u32 m0, s53, 98304
    s_add_u32 s43, s46, 1966080
    buffer_load_dwordx4 v4, s[16:19], s43 offen lds
    s_add_u32 m0, s53, 99328
    s_add_u32 s43, s47, 1966080
    buffer_load_dwordx4 v4, s[16:19], s43 offen lds
    s_add_u32 m0, s53, 100352
    s_add_u32 s43, s48, 1966080
    buffer_load_dwordx4 v4, s[16:19], s43 offen lds
    s_add_u32 m0, s53, 101376
    s_add_u32 s43, s49, 1966080
    buffer_load_dwordx4 v4, s[16:19], s43 offen lds
    s_add_u32 m0, s53, 102400
    s_add_u32 s43, s50, 1966080
    buffer_load_dwordx4 v4, s[16:19], s43 offen lds
    s_add_u32 m0, s53, 103424
    s_add_u32 s43, s51, 1966080
    buffer_load_dwordx4 v4, s[16:19], s43 offen lds
    s_waitcnt vmcnt(10)
    s_barrier
    s_add_u32 m0, s52, 0
    s_add_u32 s43, s44, 768
    buffer_load_dwordx4 v2, s[12:15], s43 offen lds
    s_add_u32 m0, s52, 1024
    s_add_u32 s43, s44, 17152
    buffer_load_dwordx4 v3, s[12:15], s43 offen lds
    s_add_u32 m0, s52, 2048
    s_add_u32 s43, s44, 33536
    buffer_load_dwordx4 v2, s[12:15], s43 offen lds
    s_add_u32 m0, s52, 3072
    s_add_u32 s43, s44, 49920
    buffer_load_dwordx4 v3, s[12:15], s43 offen lds
    s_add_u32 m0, s53, 16384
    s_add_u32 s43, s46, 2359296
    buffer_load_dwordx4 v4, s[16:19], s43 offen lds
    s_add_u32 m0, s53, 17408
    s_add_u32 s43, s47, 2359296
    buffer_load_dwordx4 v4, s[16:19], s43 offen lds
    s_add_u32 m0, s53, 18432
    s_add_u32 s43, s48, 2359296
    buffer_load_dwordx4 v4, s[16:19], s43 offen lds
    s_add_u32 m0, s53, 19456
    s_add_u32 s43, s49, 2359296
    buffer_load_dwordx4 v4, s[16:19], s43 offen lds
    s_add_u32 m0, s53, 20480
    s_add_u32 s43, s50, 2359296
    buffer_load_dwordx4 v4, s[16:19], s43 offen lds
    s_add_u32 m0, s53, 21504
    s_add_u32 s43, s51, 2359296
    buffer_load_dwordx4 v4, s[16:19], s43 offen lds
    s_waitcnt vmcnt(10)
    s_barrier
    s_add_u32 m0, s52, 40960
    s_add_u32 s43, s44, 896
    buffer_load_dwordx4 v2, s[12:15], s43 offen lds
    s_add_u32 m0, s52, 41984
    s_add_u32 s43, s44, 17280
    buffer_load_dwordx4 v3, s[12:15], s43 offen lds
    s_add_u32 m0, s52, 43008
    s_add_u32 s43, s44, 33664
    buffer_load_dwordx4 v2, s[12:15], s43 offen lds
    s_add_u32 m0, s52, 44032
    s_add_u32 s43, s44, 50048
    buffer_load_dwordx4 v3, s[12:15], s43 offen lds
    s_add_u32 m0, s53, 57344
    s_add_u32 s43, s46, 2752512
    buffer_load_dwordx4 v4, s[16:19], s43 offen lds
    s_add_u32 m0, s53, 58368
    s_add_u32 s43, s47, 2752512
    buffer_load_dwordx4 v4, s[16:19], s43 offen lds
    s_add_u32 m0, s53, 59392
    s_add_u32 s43, s48, 2752512
    buffer_load_dwordx4 v4, s[16:19], s43 offen lds
    s_add_u32 m0, s53, 60416
    s_add_u32 s43, s49, 2752512
    buffer_load_dwordx4 v4, s[16:19], s43 offen lds
    s_add_u32 m0, s53, 61440
    s_add_u32 s43, s50, 2752512
    buffer_load_dwordx4 v4, s[16:19], s43 offen lds
    s_add_u32 m0, s53, 62464
    s_add_u32 s43, s51, 2752512
    buffer_load_dwordx4 v4, s[16:19], s43 offen lds
    s_waitcnt vmcnt(10)
    s_barrier
    s_add_u32 m0, s52, 81920
    s_add_u32 s43, s44, 1024
    buffer_load_dwordx4 v2, s[12:15], s43 offen lds
    s_add_u32 m0, s52, 82944
    s_add_u32 s43, s44, 17408
    buffer_load_dwordx4 v3, s[12:15], s43 offen lds
    s_add_u32 m0, s52, 83968
    s_add_u32 s43, s44, 33792
    buffer_load_dwordx4 v2, s[12:15], s43 offen lds
    s_add_u32 m0, s52, 84992
    s_add_u32 s43, s44, 50176
    buffer_load_dwordx4 v3, s[12:15], s43 offen lds
    s_add_u32 m0, s53, 98304
    s_add_u32 s43, s46, 3145728
    buffer_load_dwordx4 v4, s[16:19], s43 offen lds
    s_add_u32 m0, s53, 99328
    s_add_u32 s43, s47, 3145728
    buffer_load_dwordx4 v4, s[16:19], s43 offen lds
    s_add_u32 m0, s53, 100352
    s_add_u32 s43, s48, 3145728
    buffer_load_dwordx4 v4, s[16:19], s43 offen lds
    s_add_u32 m0, s53, 101376
    s_add_u32 s43, s49, 3145728
    buffer_load_dwordx4 v4, s[16:19], s43 offen lds
    s_add_u32 m0, s53, 102400
    s_add_u32 s43, s50, 3145728
    buffer_load_dwordx4 v4, s[16:19], s43 offen lds
    s_add_u32 m0, s53, 103424
    s_add_u32 s43, s51, 3145728
    buffer_load_dwordx4 v4, s[16:19], s43 offen lds
    s_waitcnt vmcnt(10)
    s_barrier
    s_add_u32 m0, s52, 0
    s_add_u32 s43, s44, 1152
    buffer_load_dwordx4 v2, s[12:15], s43 offen lds
    s_add_u32 m0, s52, 1024
    s_add_u32 s43, s44, 17536
    buffer_load_dwordx4 v3, s[12:15], s43 offen lds
    s_add_u32 m0, s52, 2048
    s_add_u32 s43, s44, 33920
    buffer_load_dwordx4 v2, s[12:15], s43 offen lds
    s_add_u32 m0, s52, 3072
    s_add_u32 s43, s44, 50304
    buffer_load_dwordx4 v3, s[12:15], s43 offen lds
    s_add_u32 m0, s53, 16384
    s_add_u32 s43, s46, 3538944
    buffer_load_dwordx4 v4, s[16:19], s43 offen lds
    s_add_u32 m0, s53, 17408
    s_add_u32 s43, s47, 3538944
    buffer_load_dwordx4 v4, s[16:19], s43 offen lds
    s_add_u32 m0, s53, 18432
    s_add_u32 s43, s48, 3538944
    buffer_load_dwordx4 v4, s[16:19], s43 offen lds
    s_add_u32 m0, s53, 19456
    s_add_u32 s43, s49, 3538944
    buffer_load_dwordx4 v4, s[16:19], s43 offen lds
    s_add_u32 m0, s53, 20480
    s_add_u32 s43, s50, 3538944
    buffer_load_dwordx4 v4, s[16:19], s43 offen lds
    s_add_u32 m0, s53, 21504
    s_add_u32 s43, s51, 3538944
    buffer_load_dwordx4 v4, s[16:19], s43 offen lds
    s_waitcnt vmcnt(10)
    s_barrier
    s_add_u32 m0, s52, 40960
    s_add_u32 s43, s44, 1280
    buffer_load_dwordx4 v2, s[12:15], s43 offen lds
    s_add_u32 m0, s52, 41984
    s_add_u32 s43, s44, 17664
    buffer_load_dwordx4 v3, s[12:15], s43 offen lds
    s_add_u32 m0, s52, 43008
    s_add_u32 s43, s44, 34048
    buffer_load_dwordx4 v2, s[12:15], s43 offen lds
    s_add_u32 m0, s52, 44032
    s_add_u32 s43, s44, 50432
    buffer_load_dwordx4 v3, s[12:15], s43 offen lds
    s_add_u32 m0, s53, 57344
    s_add_u32 s43, s46, 3932160
    buffer_load_dwordx4 v4, s[16:19], s43 offen lds
    s_add_u32 m0, s53, 58368
    s_add_u32 s43, s47, 3932160
    buffer_load_dwordx4 v4, s[16:19], s43 offen lds
    s_add_u32 m0, s53, 59392
    s_add_u32 s43, s48, 3932160
    buffer_load_dwordx4 v4, s[16:19], s43 offen lds
    s_add_u32 m0, s53, 60416
    s_add_u32 s43, s49, 3932160
    buffer_load_dwordx4 v4, s[16:19], s43 offen lds
    s_add_u32 m0, s53, 61440
    s_add_u32 s43, s50, 3932160
    buffer_load_dwordx4 v4, s[16:19], s43 offen lds
    s_add_u32 m0, s53, 62464
    s_add_u32 s43, s51, 3932160
    buffer_load_dwordx4 v4, s[16:19], s43 offen lds
    s_waitcnt vmcnt(10)
    s_barrier
    s_add_u32 m0, s52, 81920
    s_add_u32 s43, s44, 1408
    buffer_load_dwordx4 v2, s[12:15], s43 offen lds
    s_add_u32 m0, s52, 82944
    s_add_u32 s43, s44, 17792
    buffer_load_dwordx4 v3, s[12:15], s43 offen lds
    s_add_u32 m0, s52, 83968
    s_add_u32 s43, s44, 34176
    buffer_load_dwordx4 v2, s[12:15], s43 offen lds
    s_add_u32 m0, s52, 84992
    s_add_u32 s43, s44, 50560
    buffer_load_dwordx4 v3, s[12:15], s43 offen lds
    s_add_u32 m0, s53, 98304
    s_add_u32 s43, s46, 4325376
    buffer_load_dwordx4 v4, s[16:19], s43 offen lds
    s_add_u32 m0, s53, 99328
    s_add_u32 s43, s47, 4325376
    buffer_load_dwordx4 v4, s[16:19], s43 offen lds
    s_add_u32 m0, s53, 100352
    s_add_u32 s43, s48, 4325376
    buffer_load_dwordx4 v4, s[16:19], s43 offen lds
    s_add_u32 m0, s53, 101376
    s_add_u32 s43, s49, 4325376
    buffer_load_dwordx4 v4, s[16:19], s43 offen lds
    s_add_u32 m0, s53, 102400
    s_add_u32 s43, s50, 4325376
    buffer_load_dwordx4 v4, s[16:19], s43 offen lds
    s_add_u32 m0, s53, 103424
    s_add_u32 s43, s51, 4325376
    buffer_load_dwordx4 v4, s[16:19], s43 offen lds
    s_waitcnt vmcnt(10)
    s_barrier
    s_add_u32 m0, s52, 0
    s_add_u32 s43, s44, 1536
    buffer_load_dwordx4 v2, s[12:15], s43 offen lds
    s_add_u32 m0, s52, 1024
    s_add_u32 s43, s44, 17920
    buffer_load_dwordx4 v3, s[12:15], s43 offen lds
    s_add_u32 m0, s52, 2048
    s_add_u32 s43, s44, 34304
    buffer_load_dwordx4 v2, s[12:15], s43 offen lds
    s_add_u32 m0, s52, 3072
    s_add_u32 s43, s44, 50688
    buffer_load_dwordx4 v3, s[12:15], s43 offen lds
    s_add_u32 m0, s53, 16384
    s_add_u32 s43, s46, 4718592
    buffer_load_dwordx4 v4, s[16:19], s43 offen lds
    s_add_u32 m0, s53, 17408
    s_add_u32 s43, s47, 4718592
    buffer_load_dwordx4 v4, s[16:19], s43 offen lds
    s_add_u32 m0, s53, 18432
    s_add_u32 s43, s48, 4718592
    buffer_load_dwordx4 v4, s[16:19], s43 offen lds
    s_add_u32 m0, s53, 19456
    s_add_u32 s43, s49, 4718592
    buffer_load_dwordx4 v4, s[16:19], s43 offen lds
    s_add_u32 m0, s53, 20480
    s_add_u32 s43, s50, 4718592
    buffer_load_dwordx4 v4, s[16:19], s43 offen lds
    s_add_u32 m0, s53, 21504
    s_add_u32 s43, s51, 4718592
    buffer_load_dwordx4 v4, s[16:19], s43 offen lds
    s_waitcnt vmcnt(10)
    s_barrier
    s_add_u32 m0, s52, 40960
    s_add_u32 s43, s44, 1664
    buffer_load_dwordx4 v2, s[12:15], s43 offen lds
    s_add_u32 m0, s52, 41984
    s_add_u32 s43, s44, 18048
    buffer_load_dwordx4 v3, s[12:15], s43 offen lds
    s_add_u32 m0, s52, 43008
    s_add_u32 s43, s44, 34432
    buffer_load_dwordx4 v2, s[12:15], s43 offen lds
    s_add_u32 m0, s52, 44032
    s_add_u32 s43, s44, 50816
    buffer_load_dwordx4 v3, s[12:15], s43 offen lds
    s_add_u32 m0, s53, 57344
    s_add_u32 s43, s46, 5111808
    buffer_load_dwordx4 v4, s[16:19], s43 offen lds
    s_add_u32 m0, s53, 58368
    s_add_u32 s43, s47, 5111808
    buffer_load_dwordx4 v4, s[16:19], s43 offen lds
    s_add_u32 m0, s53, 59392
    s_add_u32 s43, s48, 5111808
    buffer_load_dwordx4 v4, s[16:19], s43 offen lds
    s_add_u32 m0, s53, 60416
    s_add_u32 s43, s49, 5111808
    buffer_load_dwordx4 v4, s[16:19], s43 offen lds
    s_add_u32 m0, s53, 61440
    s_add_u32 s43, s50, 5111808
    buffer_load_dwordx4 v4, s[16:19], s43 offen lds
    s_add_u32 m0, s53, 62464
    s_add_u32 s43, s51, 5111808
    buffer_load_dwordx4 v4, s[16:19], s43 offen lds
    s_waitcnt vmcnt(10)
    s_barrier
    s_add_u32 m0, s52, 81920
    s_add_u32 s43, s44, 1792
    buffer_load_dwordx4 v2, s[12:15], s43 offen lds
    s_add_u32 m0, s52, 82944
    s_add_u32 s43, s44, 18176
    buffer_load_dwordx4 v3, s[12:15], s43 offen lds
    s_add_u32 m0, s52, 83968
    s_add_u32 s43, s44, 34560
    buffer_load_dwordx4 v2, s[12:15], s43 offen lds
    s_add_u32 m0, s52, 84992
    s_add_u32 s43, s44, 50944
    buffer_load_dwordx4 v3, s[12:15], s43 offen lds
    s_add_u32 m0, s53, 98304
    s_add_u32 s43, s46, 5505024
    buffer_load_dwordx4 v4, s[16:19], s43 offen lds
    s_add_u32 m0, s53, 99328
    s_add_u32 s43, s47, 5505024
    buffer_load_dwordx4 v4, s[16:19], s43 offen lds
    s_add_u32 m0, s53, 100352
    s_add_u32 s43, s48, 5505024
    buffer_load_dwordx4 v4, s[16:19], s43 offen lds
    s_add_u32 m0, s53, 101376
    s_add_u32 s43, s49, 5505024
    buffer_load_dwordx4 v4, s[16:19], s43 offen lds
    s_add_u32 m0, s53, 102400
    s_add_u32 s43, s50, 5505024
    buffer_load_dwordx4 v4, s[16:19], s43 offen lds
    s_add_u32 m0, s53, 103424
    s_add_u32 s43, s51, 5505024
    buffer_load_dwordx4 v4, s[16:19], s43 offen lds
    s_waitcnt vmcnt(10)
    s_barrier
    s_add_u32 m0, s52, 0
    s_add_u32 s43, s44, 1920
    buffer_load_dwordx4 v2, s[12:15], s43 offen lds
    s_add_u32 m0, s52, 1024
    s_add_u32 s43, s44, 18304
    buffer_load_dwordx4 v3, s[12:15], s43 offen lds
    s_add_u32 m0, s52, 2048
    s_add_u32 s43, s44, 34688
    buffer_load_dwordx4 v2, s[12:15], s43 offen lds
    s_add_u32 m0, s52, 3072
    s_add_u32 s43, s44, 51072
    buffer_load_dwordx4 v3, s[12:15], s43 offen lds
    s_add_u32 m0, s53, 16384
    s_add_u32 s43, s46, 5898240
    buffer_load_dwordx4 v4, s[16:19], s43 offen lds
    s_add_u32 m0, s53, 17408
    s_add_u32 s43, s47, 5898240
    buffer_load_dwordx4 v4, s[16:19], s43 offen lds
    s_add_u32 m0, s53, 18432
    s_add_u32 s43, s48, 5898240
    buffer_load_dwordx4 v4, s[16:19], s43 offen lds
    s_add_u32 m0, s53, 19456
    s_add_u32 s43, s49, 5898240
    buffer_load_dwordx4 v4, s[16:19], s43 offen lds
    s_add_u32 m0, s53, 20480
    s_add_u32 s43, s50, 5898240
    buffer_load_dwordx4 v4, s[16:19], s43 offen lds
    s_add_u32 m0, s53, 21504
    s_add_u32 s43, s51, 5898240
    buffer_load_dwordx4 v4, s[16:19], s43 offen lds
    s_waitcnt vmcnt(10)
    s_barrier
    s_waitcnt vmcnt(0)
    s_barrier
    s_cmp_lg_u32 s3, 4
    s_cbranch_scc1 Lnrf
    v_mov_b32 v250, 0
    s_mov_b32 s99, 0
    Lpoll_r1:
    buffer_load_dword v251, v250, s[88:91], 0 offen sc1
    s_waitcnt vmcnt(0)
    v_readfirstlane_b32 s5, v251
    s_nop 3
    s_cmp_ge_u32 s5, 1
    s_cbranch_scc1 Lpoll_r1_done
    s_sleep 2
    s_add_u32 s99, s99, 1
    s_cmp_lt_u32 s99, 0x40000
    s_cbranch_scc1 Lpoll_r1
    Lpoll_r1_done:
Lnrf:
    s_load_dwordx4 s[60:63], s[0:1], 0
    s_load_dwordx2 s[64:65], s[0:1], 16
    s_load_dwordx2 s[66:67], s[0:1], 32
    s_load_dwordx2 s[68:69], s[0:1], 72
    s_lshl_b32 s5, s2, 2
    s_and_b32 s70, s3, 3
    s_add_u32 s5, s5, s70
    v_lshlrev_b32 v252, 6, v0
    s_lshl_b32 s70, s5, 12
    s_waitcnt lgkmcnt(0)
    s_mov_b32 s72, s62
    s_mov_b32 s73, s63
    s_mov_b32 s74, 4194304
    s_mov_b32 s75, 0x00020000
    buffer_load_dword v253, v252, s[72:75], s70 offen
    s_mov_b32 s72, s64
    s_mov_b32 s73, s65
    s_mov_b32 s74, 4194304
    s_mov_b32 s75, 0x00020000
    buffer_load_dword v253, v252, s[72:75], s70 offen
    s_mov_b32 s72, s66
    s_mov_b32 s73, s67
    s_mov_b32 s74, 4194304
    s_mov_b32 s75, 0x00020000
    buffer_load_dword v253, v252, s[72:75], s70 offen
    s_mov_b32 s72, s60
    s_mov_b32 s73, s61
    s_mov_b32 s74, 4194304
    s_mov_b32 s75, 0x00020000
    buffer_load_dword v253, v252, s[72:75], s70 offen
    v_and_b32 v252, 31, v0
    v_lshlrev_b32 v252, 6, v252
    s_lshl_b32 s70, s5, 11
    s_mov_b32 s72, s68
    s_mov_b32 s73, s69
    s_mov_b32 s74, 2097152
    s_mov_b32 s75, 0x00020000
    buffer_load_dword v253, v252, s[72:75], s70 offen
    s_barrier
    v_lshlrev_b32 v53, 4, v0
    s_sub_u32 s38, s3, 4
    s_mul_i32 s38, s38, 6144
    s_add_u32 s38, s38, 126976
    v_add_u32 v54, s38, v53
    ds_read_b128 v[96:99], v54 offset:0
    ds_read_b128 v[100:103], v54 offset:1024
    ds_read_b128 v[128:131], v54 offset:2048
    ds_read_b128 v[132:135], v54 offset:3072
    ds_read_b128 v[64:67], v54 offset:4096
    ds_read_b128 v[68:71], v54 offset:5120
Lp1_epi:
    v_lshrrev_b32 v51, 5, v0
    v_lshrrev_b32 v40, 5, v0
    v_lshlrev_b32 v40, 2, v40
    v_bfe_u32 v50, v0, 2, 2
    v_add_u32 v40, v40, v50
    v_lshlrev_b32 v40, 6, v40
    v_bfe_u32 v50, v0, 4, 1
    v_lshl_add_u32 v40, v50, 5, v40
    v_and_b32 v50, 3, v0
    v_lshl_add_u32 v50, v50, 3, v40
    s_and_b32 s38, s3, 1
    s_lshl_b32 s38, s38, 11
    s_add_u32 s38, s38, 122880
    v_add_u32 v50, s38, v50
    ds_read_b64_tr_b16 v[32:33], v50 offset:0
    ds_read_b64_tr_b16 v[34:35], v50 offset:512
    ds_read_b64_tr_b16 v[36:37], v50 offset:1024
    ds_read_b64_tr_b16 v[38:39], v50 offset:1536
    v_and_b32 v40, 31, v0
    v_lshlrev_b32 v41, 2, v51
    v_sub_u32 v40, v40, v41
    v_mov_b32 v42, 0x3f80
    v_mov_b32 v43, 0x3f800000
    v_cmp_eq_u32 vcc, 0, v40
    v_cmp_eq_u32 s[28:29], 1, v40
    s_nop 0
    v_cndmask_b32 v24, 0, v42, vcc
    v_cndmask_b32 v41, 0, v43, s[28:29]
    v_or_b32 v24, v24, v41
    v_cmp_eq_u32 vcc, 2, v40
    v_cmp_eq_u32 s[28:29], 3, v40
    s_nop 0
    v_cndmask_b32 v25, 0, v42, vcc
    v_cndmask_b32 v41, 0, v43, s[28:29]
    v_or_b32 v25, v25, v41
    v_cmp_eq_u32 vcc, 8, v40
    v_cmp_eq_u32 s[28:29], 9, v40
    s_nop 0
    v_cndmask_b32 v26, 0, v42, vcc
    v_cndmask_b32 v41, 0, v43, s[28:29]
    v_or_b32 v26, v26, v41
    v_cmp_eq_u32 vcc, 10, v40
    v_cmp_eq_u32 s[28:29], 11, v40
    s_nop 0
    v_cndmask_b32 v27, 0, v42, vcc
    v_cndmask_b32 v41, 0, v43, s[28:29]
    v_or_b32 v27, v27, v41
    v_cmp_eq_u32 vcc, 16, v40
    v_cmp_eq_u32 s[28:29], 17, v40
    s_nop 0
    v_cndmask_b32 v28, 0, v42, vcc
    v_cndmask_b32 v41, 0, v43, s[28:29]
    v_or_b32 v28, v28, v41
    v_cmp_eq_u32 vcc, 18, v40
    v_cmp_eq_u32 s[28:29], 19, v40
    s_nop 0
    v_cndmask_b32 v29, 0, v42, vcc
    v_cndmask_b32 v41, 0, v43, s[28:29]
    v_or_b32 v29, v29, v41
    v_cmp_eq_u32 vcc, 24, v40
    v_cmp_eq_u32 s[28:29], 25, v40
    s_nop 0
    v_cndmask_b32 v30, 0, v42, vcc
    v_cndmask_b32 v41, 0, v43, s[28:29]
    v_or_b32 v30, v30, v41
    v_cmp_eq_u32 vcc, 26, v40
    v_cmp_eq_u32 s[28:29], 27, v40
    s_nop 0
    v_cndmask_b32 v31, 0, v42, vcc
    v_cndmask_b32 v41, 0, v43, s[28:29]
    v_or_b32 v31, v31, v41
    s_waitcnt lgkmcnt(0)
    v_mfma_f32_32x32x16_bf16 v[160:175], v[32:35], v[96:99], 0
    v_mfma_f32_32x32x16_bf16 v[160:175], v[36:39], v[100:103], v[160:175]
    s_nop 7
    s_nop 4
    v_cvt_pk_bf16_f32 v40, v160, v161
    v_lshlrev_b32 v160, 16, v40
    v_and_b32 v161, 0xffff0000, v40
    v_cvt_pk_bf16_f32 v40, v162, v163
    v_lshlrev_b32 v162, 16, v40
    v_and_b32 v163, 0xffff0000, v40
    v_cvt_pk_bf16_f32 v40, v164, v165
    v_lshlrev_b32 v164, 16, v40
    v_and_b32 v165, 0xffff0000, v40
    v_cvt_pk_bf16_f32 v40, v166, v167
    v_lshlrev_b32 v166, 16, v40
    v_and_b32 v167, 0xffff0000, v40
    v_cvt_pk_bf16_f32 v40, v168, v169
    v_lshlrev_b32 v168, 16, v40
    v_and_b32 v169, 0xffff0000, v40
    v_cvt_pk_bf16_f32 v40, v170, v171
    v_lshlrev_b32 v170, 16, v40
    v_and_b32 v171, 0xffff0000, v40
    v_cvt_pk_bf16_f32 v40, v172, v173
    v_lshlrev_b32 v172, 16, v40
    v_and_b32 v173, 0xffff0000, v40
    v_cvt_pk_bf16_f32 v40, v174, v175
    v_lshlrev_b32 v174, 16, v40
    v_and_b32 v175, 0xffff0000, v40
    v_max3_f32 v41, v160, v161, v162
    v_min3_f32 v42, v160, v161, v162
    v_max3_f32 v41, v41, v163, v164
    v_min3_f32 v42, v42, v163, v164
    v_max3_f32 v41, v41, v165, v166
    v_min3_f32 v42, v42, v165, v166
    v_max3_f32 v41, v41, v167, v168
    v_min3_f32 v42, v42, v167, v168
    v_max3_f32 v41, v41, v169, v170
    v_min3_f32 v42, v42, v169, v170
    v_max3_f32 v41, v41, v171, v172
    v_min3_f32 v42, v42, v171, v172
    v_max3_f32 v41, v41, v173, v174
    v_min3_f32 v42, v42, v173, v174
    v_max_f32 v41, v41, v175
    v_min_f32 v42, v42, v175
    v_mov_b32 v45, v41
    v_mov_b32 v46, v41
    s_nop 1
    v_permlane32_swap_b32 v45, v46
    s_nop 1
    v_max_f32 v41, v45, v46
    v_mov_b32 v45, v42
    v_mov_b32 v46, v42
    s_nop 1
    v_permlane32_swap_b32 v45, v46
    s_nop 1
    v_min_f32 v42, v45, v46
    v_mul_f32 v41, s40, v41
    v_mul_f32 v42, s40, v42
    v_fma_f32 v176, v160, s40, -v41
    v_fma_f32 v160, -v160, s40, v42
    v_exp_f32 v176, v176
    v_exp_f32 v160, v160
    v_fma_f32 v177, v161, s40, -v41
    v_fma_f32 v161, -v161, s40, v42
    v_exp_f32 v177, v177
    v_exp_f32 v161, v161
    v_fma_f32 v178, v162, s40, -v41
    v_fma_f32 v162, -v162, s40, v42
    v_exp_f32 v178, v178
    v_exp_f32 v162, v162
    v_fma_f32 v179, v163, s40, -v41
    v_fma_f32 v163, -v163, s40, v42
    v_exp_f32 v179, v179
    v_exp_f32 v163, v163
    v_fma_f32 v180, v164, s40, -v41
    v_fma_f32 v164, -v164, s40, v42
    v_exp_f32 v180, v180
    v_exp_f32 v164, v164
    v_fma_f32 v181, v165, s40, -v41
    v_fma_f32 v165, -v165, s40, v42
    v_exp_f32 v181, v181
    v_exp_f32 v165, v165
    v_fma_f32 v182, v166, s40, -v41
    v_fma_f32 v166, -v166, s40, v42
    v_exp_f32 v182, v182
    v_exp_f32 v166, v166
    v_fma_f32 v183, v167, s40, -v41
    v_fma_f32 v167, -v167, s40, v42
    v_exp_f32 v183, v183
    v_exp_f32 v167, v167
    v_fma_f32 v184, v168, s40, -v41
    v_fma_f32 v168, -v168, s40, v42
    v_exp_f32 v184, v184
    v_exp_f32 v168, v168
    v_fma_f32 v185, v169, s40, -v41
    v_fma_f32 v169, -v169, s40, v42
    v_exp_f32 v185, v185
    v_exp_f32 v169, v169
    v_fma_f32 v186, v170, s40, -v41
    v_fma_f32 v170, -v170, s40, v42
    v_exp_f32 v186, v186
    v_exp_f32 v170, v170
    v_fma_f32 v187, v171, s40, -v41
    v_fma_f32 v171, -v171, s40, v42
    v_exp_f32 v187, v187
    v_exp_f32 v171, v171
    v_fma_f32 v188, v172, s40, -v41
    v_fma_f32 v172, -v172, s40, v42
    v_exp_f32 v188, v188
    v_exp_f32 v172, v172
    v_fma_f32 v189, v173, s40, -v41
    v_fma_f32 v173, -v173, s40, v42
    v_exp_f32 v189, v189
    v_exp_f32 v173, v173
    v_fma_f32 v190, v174, s40, -v41
    v_fma_f32 v174, -v174, s40, v42
    v_exp_f32 v190, v190
    v_exp_f32 v174, v174
    v_fma_f32 v191, v175, s40, -v41
    v_fma_f32 v175, -v175, s40, v42
    v_exp_f32 v191, v191
    v_exp_f32 v175, v175
    s_nop 0
    v_add_f32 v43, v176, v177
    v_add_f32 v44, v160, v161
    v_add_f32 v43, v43, v178
    v_add_f32 v44, v44, v162
    v_add_f32 v43, v43, v179
    v_add_f32 v44, v44, v163
    v_add_f32 v43, v43, v180
    v_add_f32 v44, v44, v164
    v_add_f32 v43, v43, v181
    v_add_f32 v44, v44, v165
    v_add_f32 v43, v43, v182
    v_add_f32 v44, v44, v166
    v_add_f32 v43, v43, v183
    v_add_f32 v44, v44, v167
    v_add_f32 v43, v43, v184
    v_add_f32 v44, v44, v168
    v_add_f32 v43, v43, v185
    v_add_f32 v44, v44, v169
    v_add_f32 v43, v43, v186
    v_add_f32 v44, v44, v170
    v_add_f32 v43, v43, v187
    v_add_f32 v44, v44, v171
    v_add_f32 v43, v43, v188
    v_add_f32 v44, v44, v172
    v_add_f32 v43, v43, v189
    v_add_f32 v44, v44, v173
    v_add_f32 v43, v43, v190
    v_add_f32 v44, v44, v174
    v_add_f32 v43, v43, v191
    v_add_f32 v44, v44, v175
    v_mov_b32 v45, v43
    v_mov_b32 v46, v43
    s_nop 1
    v_permlane32_swap_b32 v45, v46
    s_nop 1
    v_add_f32 v43, v45, v46
    v_mov_b32 v45, v44
    v_mov_b32 v46, v44
    s_nop 1
    v_permlane32_swap_b32 v45, v46
    s_nop 1
    v_add_f32 v44, v45, v46
    v_rcp_f32 v43, v43
    v_rcp_f32 v44, v44
    s_nop 0
    v_mul_f32 v176, v176, v43
    v_mul_f32 v160, v160, v44
    v_mul_f32 v177, v177, v43
    v_mul_f32 v161, v161, v44
    v_mul_f32 v178, v178, v43
    v_mul_f32 v162, v162, v44
    v_mul_f32 v179, v179, v43
    v_mul_f32 v163, v163, v44
    v_mul_f32 v180, v180, v43
    v_mul_f32 v164, v164, v44
    v_mul_f32 v181, v181, v43
    v_mul_f32 v165, v165, v44
    v_mul_f32 v182, v182, v43
    v_mul_f32 v166, v166, v44
    v_mul_f32 v183, v183, v43
    v_mul_f32 v167, v167, v44
    v_mul_f32 v184, v184, v43
    v_mul_f32 v168, v168, v44
    v_mul_f32 v185, v185, v43
    v_mul_f32 v169, v169, v44
    v_mul_f32 v186, v186, v43
    v_mul_f32 v170, v170, v44
    v_mul_f32 v187, v187, v43
    v_mul_f32 v171, v171, v44
    v_mul_f32 v188, v188, v43
    v_mul_f32 v172, v172, v44
    v_mul_f32 v189, v189, v43
    v_mul_f32 v173, v173, v44
    v_mul_f32 v190, v190, v43
    v_mul_f32 v174, v174, v44
    v_mul_f32 v191, v191, v43
    v_mul_f32 v175, v175, v44
    v_cvt_pk_bf16_f32 v192, v176, v177
    v_cvt_pk_bf16_f32 v200, v160, v161
    v_cvt_pk_bf16_f32 v193, v178, v179
    v_cvt_pk_bf16_f32 v201, v162, v163
    v_cvt_pk_bf16_f32 v194, v180, v181
    v_cvt_pk_bf16_f32 v202, v164, v165
    v_cvt_pk_bf16_f32 v195, v182, v183
    v_cvt_pk_bf16_f32 v203, v166, v167
    v_cvt_pk_bf16_f32 v196, v184, v185
    v_cvt_pk_bf16_f32 v204, v168, v169
    v_cvt_pk_bf16_f32 v197, v186, v187
    v_cvt_pk_bf16_f32 v205, v170, v171
    v_cvt_pk_bf16_f32 v198, v188, v189
    v_cvt_pk_bf16_f32 v206, v172, v173
    v_cvt_pk_bf16_f32 v199, v190, v191
    v_cvt_pk_bf16_f32 v207, v174, v175
    s_nop 1
    v_mfma_f32_32x32x16_bf16 v[208:223], v[192:195], v[24:27], 0
    v_mfma_f32_32x32x16_bf16 v[208:223], v[196:199], v[28:31], v[208:223]
    v_mfma_f32_32x32x16_bf16 v[160:175], v[200:203], v[24:27], 0
    v_mfma_f32_32x32x16_bf16 v[160:175], v[204:207], v[28:31], v[160:175]
    s_nop 7
    s_nop 4
    v_cvt_pk_bf16_f32 v176, v208, v209
    v_cvt_pk_bf16_f32 v177, v210, v211
    v_cvt_pk_bf16_f32 v178, v212, v213
    v_cvt_pk_bf16_f32 v179, v214, v215
    v_cvt_pk_bf16_f32 v180, v216, v217
    v_cvt_pk_bf16_f32 v181, v218, v219
    v_cvt_pk_bf16_f32 v182, v220, v221
    v_cvt_pk_bf16_f32 v183, v222, v223
    v_cvt_pk_bf16_f32 v184, v160, v161
    v_cvt_pk_bf16_f32 v185, v162, v163
    v_cvt_pk_bf16_f32 v186, v164, v165
    v_cvt_pk_bf16_f32 v187, v166, v167
    v_cvt_pk_bf16_f32 v188, v168, v169
    v_cvt_pk_bf16_f32 v189, v170, v171
    v_cvt_pk_bf16_f32 v190, v172, v173
    v_cvt_pk_bf16_f32 v191, v174, v175
    s_nop 1
    v_mfma_f32_32x32x16_bf16 v[112:127], v[176:179], v[128:131], 0
    v_mfma_f32_32x32x16_bf16 v[112:127], v[180:183], v[132:135], v[112:127]
    v_mfma_f32_32x32x16_bf16 v[192:207], v[184:187], v[128:131], 0
    v_mfma_f32_32x32x16_bf16 v[192:207], v[188:191], v[132:135], v[192:207]
    v_add_f32 v48, v208, v209
    v_add_f32 v48, v48, v210
    v_add_f32 v48, v48, v211
    v_add_f32 v48, v48, v212
    v_add_f32 v48, v48, v213
    v_add_f32 v48, v48, v214
    v_add_f32 v48, v48, v215
    v_add_f32 v48, v48, v216
    v_add_f32 v48, v48, v217
    v_add_f32 v48, v48, v218
    v_add_f32 v48, v48, v219
    v_add_f32 v48, v48, v220
    v_add_f32 v48, v48, v221
    v_add_f32 v48, v48, v222
    v_add_f32 v48, v48, v223
    v_add_f32 v49, v160, v161
    v_add_f32 v49, v49, v162
    v_add_f32 v49, v49, v163
    v_add_f32 v49, v49, v164
    v_add_f32 v49, v49, v165
    v_add_f32 v49, v49, v166
    v_add_f32 v49, v49, v167
    v_add_f32 v49, v49, v168
    v_add_f32 v49, v49, v169
    v_add_f32 v49, v49, v170
    v_add_f32 v49, v49, v171
    v_add_f32 v49, v49, v172
    v_add_f32 v49, v49, v173
    v_add_f32 v49, v49, v174
    v_add_f32 v49, v49, v175
    v_mov_b32 v40, v48
    v_mov_b32 v41, v48
    s_nop 1
    v_permlane32_swap_b32 v40, v41
    s_nop 1
    v_add_f32 v48, v40, v41
    v_mov_b32 v40, v49
    v_mov_b32 v41, v49
    s_nop 1
    v_permlane32_swap_b32 v40, v41
    s_nop 1
    v_add_f32 v49, v40, v41
    v_cmp_gt_u32 vcc, 32, v0
    s_nop 1
    v_cndmask_b32 v48, v49, v48, vcc
    s_mul_i32 s38, s3, 9216
    v_add_u32 v54, s38, v53
    ds_write_b128 v54, v[112:115] offset:0
    ds_write_b128 v54, v[116:119] offset:1024
    ds_write_b128 v54, v[120:123] offset:2048
    ds_write_b128 v54, v[124:127] offset:3072
    ds_write_b128 v54, v[192:195] offset:4096
    ds_write_b128 v54, v[196:199] offset:5120
    ds_write_b128 v54, v[200:203] offset:6144
    ds_write_b128 v54, v[204:207] offset:7168
    ds_write_b32 v54, v48 offset:8192
    s_waitcnt lgkmcnt(0)
    s_barrier
    s_and_b32 s38, s3, 1
    s_mul_i32 s38, s38, 9216
    s_lshr_b32 s41, s3, 1
    s_lshl_b32 s5, s41, 11
    s_add_u32 s38, s38, s5
    v_add_u32 v54, s38, v53
    ds_read_b128 v[160:163], v54 offset:0
    ds_read_b128 v[164:167], v54 offset:1024
    ds_read_b128 v[168:171], v54 offset:18432
    ds_read_b128 v[172:175], v54 offset:19456
    ds_read_b128 v[176:179], v54 offset:36864
    ds_read_b128 v[180:183], v54 offset:37888
    ds_read_b128 v[184:187], v54 offset:55296
    ds_read_b128 v[188:191], v54 offset:56320
    s_and_b32 s38, s3, 1
    s_mul_i32 s38, s38, 9216
    v_add_u32 v55, s38, v53
    ds_read_b32 v40, v55 offset:8192
    ds_read_b32 v41, v55 offset:26624
    ds_read_b32 v42, v55 offset:45056
    ds_read_b32 v43, v55 offset:63488
    s_lshl_b32 s38, s39, 4
    s_add_u32 s38, s38, s6
    s_mul_i32 s38, s38, 8448
    s_lshl_b32 s5, s41, 11
    s_add_u32 s5, s5, s38
    s_waitcnt lgkmcnt(0)
    v_add_f32 v160, v160, v168
    v_add_f32 v176, v176, v184
    v_add_f32 v160, v160, v176
    v_add_f32 v161, v161, v169
    v_add_f32 v177, v177, v185
    v_add_f32 v161, v161, v177
    v_add_f32 v162, v162, v170
    v_add_f32 v178, v178, v186
    v_add_f32 v162, v162, v178
    v_add_f32 v163, v163, v171
    v_add_f32 v179, v179, v187
    v_add_f32 v163, v163, v179
    buffer_store_dwordx4 v[160:163], v53, s[24:27], s5 offen offset:0 sc1
    v_add_f32 v164, v164, v172
    v_add_f32 v180, v180, v188
    v_add_f32 v164, v164, v180
    v_add_f32 v165, v165, v173
    v_add_f32 v181, v181, v189
    v_add_f32 v165, v165, v181
    v_add_f32 v166, v166, v174
    v_add_f32 v182, v182, v190
    v_add_f32 v166, v166, v182
    v_add_f32 v167, v167, v175
    v_add_f32 v183, v183, v191
    v_add_f32 v167, v167, v183
    buffer_store_dwordx4 v[164:167], v53, s[24:27], s5 offen offset:1024 sc1
    s_cmp_lg_u32 s41, 0
    s_cbranch_scc1 Lnoz
    v_add_f32 v40, v40, v41
    v_add_f32 v42, v42, v43
    v_add_f32 v40, v40, v42
    v_lshlrev_b32 v55, 2, v0
    s_add_u32 s38, s38, 8192
    buffer_store_dword v40, v55, s[24:27], s38 offen sc1
Lnoz:
    s_waitcnt vmcnt(0)
    s_barrier
    s_cmp_lg_u32 s3, 4
    s_cbranch_scc1 Lnosig
    s_lshl_b32 s5, s7, 8
    s_add_u32 s5, s5, 0
    v_mov_b32 v54, s5
    v_mov_b32 v55, 1
    s_mov_b64 exec, 1
    buffer_atomic_add v55, v54, s[8:11], 0 offen sc1
    s_mov_b64 exec, -1
Lnosig:
    s_lshl_b32 s56, s2, 2
    s_and_b32 s5, s3, 3
    s_add_u32 s56, s56, s5
    s_load_dwordx2 s[76:77], s[0:1], 8
    s_load_dwordx2 s[78:79], s[0:1], 16
    s_load_dwordx2 s[80:81], s[0:1], 24
    s_load_dwordx2 s[82:83], s[0:1], 96
    s_lshr_b32 s84, s56, 4
    s_and_b32 s85, s56, 15
    s_mul_i32 s84, s84, 32
    s_lshl_b32 s85, s85, 6
    v_and_b32 v97, 7, v0
    v_lshrrev_b32 v96, 3, v0
    v_mul_u32_u24 v96, 4, v96
    v_add_u32 v96, s84, v96
    v_lshlrev_b32 v97, 3, v97
    v_add_u32 v97, s85, v97
    s_waitcnt lgkmcnt(0)
    s_mov_b32 s60, s76
    s_mov_b32 s61, s77
    s_mov_b32 s62, 4194304
    s_mov_b32 s63, 0x00020000
    s_mov_b32 s64, s78
    s_mov_b32 s65, s79
    s_mov_b32 s66, 4194304
    s_mov_b32 s67, 0x00020000
    s_mov_b32 s68, s80
    s_mov_b32 s69, s81
    s_mov_b32 s70, 8192
    s_mov_b32 s71, 0x00020000
    s_mov_b32 s72, s82
    s_mov_b32 s73, s83
    s_mov_b32 s74, 4194304
    s_mov_b32 s75, 0x00020000
    v_lshlrev_b32 v98, 11, v96
    v_lshl_add_u32 v98, v97, 1, v98
    v_add_u32 v98, 4294961152, v98
    v_add_u32 v99, 2048, v98
    v_add_u32 v100, 4096, v98
    v_add_u32 v101, 6144, v98
    v_add_u32 v102, 8192, v98
    v_add_u32 v103, 10240, v98
    v_add_u32 v104, 12288, v98
    v_lshlrev_b32 v179, 3, v97
    s_cmp_lt_u32 s3, 4
    s_cbranch_scc1 Lnoap0
    buffer_load_dwordx4 v[108:111], v179, s[68:71], 0 offen offset:0
    buffer_load_dwordx4 v[112:115], v179, s[68:71], 0 offen offset:16
    buffer_load_dwordx4 v[116:119], v179, s[68:71], 0 offen offset:32
    buffer_load_dwordx4 v[120:123], v179, s[68:71], 0 offen offset:48
    buffer_load_dwordx4 v[124:127], v98, s[60:63], 0 offen
    buffer_load_dwordx4 v[128:131], v99, s[60:63], 0 offen
    buffer_load_dwordx4 v[132:135], v100, s[60:63], 0 offen
    buffer_load_dwordx4 v[136:139], v101, s[60:63], 0 offen
    buffer_load_dwordx4 v[140:143], v102, s[60:63], 0 offen
    buffer_load_dwordx4 v[144:147], v103, s[60:63], 0 offen
    buffer_load_dwordx4 v[148:151], v104, s[60:63], 0 offen
    buffer_load_dwordx4 v[152:155], v101, s[64:67], 0 offen
    buffer_load_dwordx4 v[156:159], v102, s[64:67], 0 offen
    buffer_load_dwordx4 v[160:163], v103, s[64:67], 0 offen
    buffer_load_dwordx4 v[164:167], v104, s[64:67], 0 offen
    v_sub_u32 v179, 2044, v96
    v_lshlrev_b32 v179, 1, v179
    v_lshl_add_u32 v98, v97, 12, v179
Lnoap0:
    v_mfma_f32_32x32x16_bf16 v[208:223], v[32:35], v[64:67], 0
    v_mfma_f32_32x32x16_bf16 v[208:223], v[36:39], v[68:71], v[208:223]
    s_nop 7
    s_nop 4
    v_cvt_pk_bf16_f32 v40, v208, v209
    v_lshlrev_b32 v208, 16, v40
    v_and_b32 v209, 0xffff0000, v40
    v_cvt_pk_bf16_f32 v40, v210, v211
    v_lshlrev_b32 v210, 16, v40
    v_and_b32 v211, 0xffff0000, v40
    v_cvt_pk_bf16_f32 v40, v212, v213
    v_lshlrev_b32 v212, 16, v40
    v_and_b32 v213, 0xffff0000, v40
    v_cvt_pk_bf16_f32 v40, v214, v215
    v_lshlrev_b32 v214, 16, v40
    v_and_b32 v215, 0xffff0000, v40
    v_cvt_pk_bf16_f32 v40, v216, v217
    v_lshlrev_b32 v216, 16, v40
    v_and_b32 v217, 0xffff0000, v40
    v_cvt_pk_bf16_f32 v40, v218, v219
    v_lshlrev_b32 v218, 16, v40
    v_and_b32 v219, 0xffff0000, v40
    v_cvt_pk_bf16_f32 v40, v220, v221
    v_lshlrev_b32 v220, 16, v40
    v_and_b32 v221, 0xffff0000, v40
    v_cvt_pk_bf16_f32 v40, v222, v223
    v_lshlrev_b32 v222, 16, v40
    v_and_b32 v223, 0xffff0000, v40
    v_max3_f32 v41, v208, v209, v210
    v_min3_f32 v42, v208, v209, v210
    v_max3_f32 v41, v41, v211, v212
    v_min3_f32 v42, v42, v211, v212
    v_max3_f32 v41, v41, v213, v214
    v_min3_f32 v42, v42, v213, v214
    v_max3_f32 v41, v41, v215, v216
    v_min3_f32 v42, v42, v215, v216
    v_max3_f32 v41, v41, v217, v218
    v_min3_f32 v42, v42, v217, v218
    v_max3_f32 v41, v41, v219, v220
    v_min3_f32 v42, v42, v219, v220
    v_max3_f32 v41, v41, v221, v222
    v_min3_f32 v42, v42, v221, v222
    v_max_f32 v41, v41, v223
    v_min_f32 v42, v42, v223
    v_mov_b32 v45, v41
    v_mov_b32 v46, v41
    s_nop 1
    v_permlane32_swap_b32 v45, v46
    s_nop 1
    v_max_f32 v41, v45, v46
    v_mov_b32 v45, v42
    v_mov_b32 v46, v42
    s_nop 1
    v_permlane32_swap_b32 v45, v46
    s_nop 1
    v_min_f32 v42, v45, v46
    v_mul_f32 v41, s40, v41
    v_mul_f32 v42, s40, v42
    v_fma_f32 v192, v208, s40, -v41
    v_fma_f32 v208, -v208, s40, v42
    v_exp_f32 v192, v192
    v_exp_f32 v208, v208
    v_fma_f32 v193, v209, s40, -v41
    v_fma_f32 v209, -v209, s40, v42
    v_exp_f32 v193, v193
    v_exp_f32 v209, v209
    v_fma_f32 v194, v210, s40, -v41
    v_fma_f32 v210, -v210, s40, v42
    v_exp_f32 v194, v194
    v_exp_f32 v210, v210
    v_fma_f32 v195, v211, s40, -v41
    v_fma_f32 v211, -v211, s40, v42
    v_exp_f32 v195, v195
    v_exp_f32 v211, v211
    v_fma_f32 v196, v212, s40, -v41
    v_fma_f32 v212, -v212, s40, v42
    v_exp_f32 v196, v196
    v_exp_f32 v212, v212
    v_fma_f32 v197, v213, s40, -v41
    v_fma_f32 v213, -v213, s40, v42
    v_exp_f32 v197, v197
    v_exp_f32 v213, v213
    v_fma_f32 v198, v214, s40, -v41
    v_fma_f32 v214, -v214, s40, v42
    v_exp_f32 v198, v198
    v_exp_f32 v214, v214
    v_fma_f32 v199, v215, s40, -v41
    v_fma_f32 v215, -v215, s40, v42
    v_exp_f32 v199, v199
    v_exp_f32 v215, v215
    v_fma_f32 v200, v216, s40, -v41
    v_fma_f32 v216, -v216, s40, v42
    v_exp_f32 v200, v200
    v_exp_f32 v216, v216
    v_fma_f32 v201, v217, s40, -v41
    v_fma_f32 v217, -v217, s40, v42
    v_exp_f32 v201, v201
    v_exp_f32 v217, v217
    v_fma_f32 v202, v218, s40, -v41
    v_fma_f32 v218, -v218, s40, v42
    v_exp_f32 v202, v202
    v_exp_f32 v218, v218
    v_fma_f32 v203, v219, s40, -v41
    v_fma_f32 v219, -v219, s40, v42
    v_exp_f32 v203, v203
    v_exp_f32 v219, v219
    v_fma_f32 v204, v220, s40, -v41
    v_fma_f32 v220, -v220, s40, v42
    v_exp_f32 v204, v204
    v_exp_f32 v220, v220
    v_fma_f32 v205, v221, s40, -v41
    v_fma_f32 v221, -v221, s40, v42
    v_exp_f32 v205, v205
    v_exp_f32 v221, v221
    v_fma_f32 v206, v222, s40, -v41
    v_fma_f32 v222, -v222, s40, v42
    v_exp_f32 v206, v206
    v_exp_f32 v222, v222
    v_fma_f32 v207, v223, s40, -v41
    v_fma_f32 v223, -v223, s40, v42
    v_exp_f32 v207, v207
    v_exp_f32 v223, v223
    s_nop 0
    v_add_f32 v43, v192, v193
    v_add_f32 v44, v208, v209
    v_add_f32 v43, v43, v194
    v_add_f32 v44, v44, v210
    v_add_f32 v43, v43, v195
    v_add_f32 v44, v44, v211
    v_add_f32 v43, v43, v196
    v_add_f32 v44, v44, v212
    v_add_f32 v43, v43, v197
    v_add_f32 v44, v44, v213
    v_add_f32 v43, v43, v198
    v_add_f32 v44, v44, v214
    v_add_f32 v43, v43, v199
    v_add_f32 v44, v44, v215
    v_add_f32 v43, v43, v200
    v_add_f32 v44, v44, v216
    v_add_f32 v43, v43, v201
    v_add_f32 v44, v44, v217
    v_add_f32 v43, v43, v202
    v_add_f32 v44, v44, v218
    v_add_f32 v43, v43, v203
    v_add_f32 v44, v44, v219
    v_add_f32 v43, v43, v204
    v_add_f32 v44, v44, v220
    v_add_f32 v43, v43, v205
    v_add_f32 v44, v44, v221
    v_add_f32 v43, v43, v206
    v_add_f32 v44, v44, v222
    v_add_f32 v43, v43, v207
    v_add_f32 v44, v44, v223
    v_mov_b32 v45, v43
    v_mov_b32 v46, v43
    s_nop 1
    v_permlane32_swap_b32 v45, v46
    s_nop 1
    v_add_f32 v43, v45, v46
    v_mov_b32 v45, v44
    v_mov_b32 v46, v44
    s_nop 1
    v_permlane32_swap_b32 v45, v46
    s_nop 1
    v_add_f32 v44, v45, v46
    v_rcp_f32 v43, v43
    v_rcp_f32 v44, v44
    s_nop 0
    v_mul_f32 v192, v192, v43
    v_mul_f32 v208, v208, v44
    v_mul_f32 v193, v193, v43
    v_mul_f32 v209, v209, v44
    v_mul_f32 v194, v194, v43
    v_mul_f32 v210, v210, v44
    v_mul_f32 v195, v195, v43
    v_mul_f32 v211, v211, v44
    v_mul_f32 v196, v196, v43
    v_mul_f32 v212, v212, v44
    v_mul_f32 v197, v197, v43
    v_mul_f32 v213, v213, v44
    v_mul_f32 v198, v198, v43
    v_mul_f32 v214, v214, v44
    v_mul_f32 v199, v199, v43
    v_mul_f32 v215, v215, v44
    v_mul_f32 v200, v200, v43
    v_mul_f32 v216, v216, v44
    v_mul_f32 v201, v201, v43
    v_mul_f32 v217, v217, v44
    v_mul_f32 v202, v202, v43
    v_mul_f32 v218, v218, v44
    v_mul_f32 v203, v203, v43
    v_mul_f32 v219, v219, v44
    v_mul_f32 v204, v204, v43
    v_mul_f32 v220, v220, v44
    v_mul_f32 v205, v205, v43
    v_mul_f32 v221, v221, v44
    v_mul_f32 v206, v206, v43
    v_mul_f32 v222, v222, v44
    v_mul_f32 v207, v207, v43
    v_mul_f32 v223, v223, v44
    v_cvt_pk_bf16_f32 v224, v192, v193
    v_cvt_pk_bf16_f32 v232, v208, v209
    v_cvt_pk_bf16_f32 v225, v194, v195
    v_cvt_pk_bf16_f32 v233, v210, v211
    v_cvt_pk_bf16_f32 v226, v196, v197
    v_cvt_pk_bf16_f32 v234, v212, v213
    v_cvt_pk_bf16_f32 v227, v198, v199
    v_cvt_pk_bf16_f32 v235, v214, v215
    v_cvt_pk_bf16_f32 v228, v200, v201
    v_cvt_pk_bf16_f32 v236, v216, v217
    v_cvt_pk_bf16_f32 v229, v202, v203
    v_cvt_pk_bf16_f32 v237, v218, v219
    v_cvt_pk_bf16_f32 v230, v204, v205
    v_cvt_pk_bf16_f32 v238, v220, v221
    v_cvt_pk_bf16_f32 v231, v206, v207
    v_cvt_pk_bf16_f32 v239, v222, v223
    s_cmp_lt_u32 s3, 4
    s_cbranch_scc1 Lnoap1
    s_waitcnt vmcnt(0)
    v_lshlrev_b32 v99, 16, v108
    v_and_b32 v100, 0xffff0000, v108
    v_lshlrev_b32 v101, 16, v109
    v_and_b32 v102, 0xffff0000, v109
    v_lshlrev_b32 v168, 16, v124
    v_lshlrev_b32 v169, 16, v128
    v_lshlrev_b32 v170, 16, v132
    v_lshlrev_b32 v171, 16, v136
    v_lshlrev_b32 v172, 16, v140
    v_lshlrev_b32 v173, 16, v144
    v_lshlrev_b32 v174, 16, v148
    v_lshlrev_b32 v175, 16, v152
    v_lshlrev_b32 v176, 16, v156
    v_lshlrev_b32 v177, 16, v160
    v_lshlrev_b32 v178, 16, v164
    v_mul_f32 v179, v168, v102
    v_mul_f32 v180, v169, v102
    v_cvt_pk_bf16_f32 v183, v179, v180
    v_lshlrev_b32 v179, 16, v183
    v_and_b32 v180, 0xffff0000, v183
    v_mul_f32 v181, v169, v101
    v_mul_f32 v182, v170, v101
    v_cvt_pk_bf16_f32 v183, v181, v182
    v_lshlrev_b32 v181, 16, v183
    v_and_b32 v182, 0xffff0000, v183
    v_add_f32 v179, v179, v181
    v_add_f32 v180, v180, v182
    v_cvt_pk_bf16_f32 v183, v179, v180
    v_lshlrev_b32 v179, 16, v183
    v_and_b32 v180, 0xffff0000, v183
    v_mul_f32 v181, v170, v100
    v_mul_f32 v182, v171, v100
    v_cvt_pk_bf16_f32 v183, v181, v182
    v_lshlrev_b32 v181, 16, v183
    v_and_b32 v182, 0xffff0000, v183
    v_add_f32 v179, v179, v181
    v_add_f32 v180, v180, v182
    v_cvt_pk_bf16_f32 v183, v179, v180
    v_lshlrev_b32 v179, 16, v183
    v_and_b32 v180, 0xffff0000, v183
    v_mul_f32 v181, v171, v99
    v_mul_f32 v182, v172, v99
    v_cvt_pk_bf16_f32 v183, v181, v182
    v_lshlrev_b32 v181, 16, v183
    v_and_b32 v182, 0xffff0000, v183
    v_add_f32 v179, v179, v181
    v_add_f32 v180, v180, v182
    v_cvt_pk_bf16_f32 v183, v179, v180
    v_lshlrev_b32 v179, 16, v183
    v_and_b32 v180, 0xffff0000, v183
    v_mul_f32 v179, v179, v175
    v_mul_f32 v180, v180, v176
    v_cvt_pk_bf16_f32 v185, v180, v179
    v_mul_f32 v179, v170, v102
    v_mul_f32 v180, v171, v102
    v_cvt_pk_bf16_f32 v183, v179, v180
    v_lshlrev_b32 v179, 16, v183
    v_and_b32 v180, 0xffff0000, v183
    v_mul_f32 v181, v171, v101
    v_mul_f32 v182, v172, v101
    v_cvt_pk_bf16_f32 v183, v181, v182
    v_lshlrev_b32 v181, 16, v183
    v_and_b32 v182, 0xffff0000, v183
    v_add_f32 v179, v179, v181
    v_add_f32 v180, v180, v182
    v_cvt_pk_bf16_f32 v183, v179, v180
    v_lshlrev_b32 v179, 16, v183
    v_and_b32 v180, 0xffff0000, v183
    v_mul_f32 v181, v172, v100
    v_mul_f32 v182, v173, v100
    v_cvt_pk_bf16_f32 v183, v181, v182
    v_lshlrev_b32 v181, 16, v183
    v_and_b32 v182, 0xffff0000, v183
    v_add_f32 v179, v179, v181
    v_add_f32 v180, v180, v182
    v_cvt_pk_bf16_f32 v183, v179, v180
    v_lshlrev_b32 v179, 16, v183
    v_and_b32 v180, 0xffff0000, v183
    v_mul_f32 v181, v173, v99
    v_mul_f32 v182, v174, v99
    v_cvt_pk_bf16_f32 v183, v181, v182
    v_lshlrev_b32 v181, 16, v183
    v_and_b32 v182, 0xffff0000, v183
    v_add_f32 v179, v179, v181
    v_add_f32 v180, v180, v182
    v_cvt_pk_bf16_f32 v183, v179, v180
    v_lshlrev_b32 v179, 16, v183
    v_and_b32 v180, 0xffff0000, v183
    v_mul_f32 v179, v179, v177
    v_mul_f32 v180, v180, v178
    v_cvt_pk_bf16_f32 v184, v180, v179
    s_mov_b32 s84, 0
    buffer_store_dwordx2 v[184:185], v98, s[72:75], s84 offen sc1
    v_lshlrev_b32 v99, 16, v110
    v_and_b32 v100, 0xffff0000, v110
    v_lshlrev_b32 v101, 16, v111
    v_and_b32 v102, 0xffff0000, v111
    v_and_b32 v168, 0xffff0000, v124
    v_and_b32 v169, 0xffff0000, v128
    v_and_b32 v170, 0xffff0000, v132
    v_and_b32 v171, 0xffff0000, v136
    v_and_b32 v172, 0xffff0000, v140
    v_and_b32 v173, 0xffff0000, v144
    v_and_b32 v174, 0xffff0000, v148
    v_and_b32 v175, 0xffff0000, v152
    v_and_b32 v176, 0xffff0000, v156
    v_and_b32 v177, 0xffff0000, v160
    v_and_b32 v178, 0xffff0000, v164
    v_mul_f32 v179, v168, v102
    v_mul_f32 v180, v169, v102
    v_cvt_pk_bf16_f32 v183, v179, v180
    v_lshlrev_b32 v179, 16, v183
    v_and_b32 v180, 0xffff0000, v183
    v_mul_f32 v181, v169, v101
    v_mul_f32 v182, v170, v101
    v_cvt_pk_bf16_f32 v183, v181, v182
    v_lshlrev_b32 v181, 16, v183
    v_and_b32 v182, 0xffff0000, v183
    v_add_f32 v179, v179, v181
    v_add_f32 v180, v180, v182
    v_cvt_pk_bf16_f32 v183, v179, v180
    v_lshlrev_b32 v179, 16, v183
    v_and_b32 v180, 0xffff0000, v183
    v_mul_f32 v181, v170, v100
    v_mul_f32 v182, v171, v100
    v_cvt_pk_bf16_f32 v183, v181, v182
    v_lshlrev_b32 v181, 16, v183
    v_and_b32 v182, 0xffff0000, v183
    v_add_f32 v179, v179, v181
    v_add_f32 v180, v180, v182
    v_cvt_pk_bf16_f32 v183, v179, v180
    v_lshlrev_b32 v179, 16, v183
    v_and_b32 v180, 0xffff0000, v183
    v_mul_f32 v181, v171, v99
    v_mul_f32 v182, v172, v99
    v_cvt_pk_bf16_f32 v183, v181, v182
    v_lshlrev_b32 v181, 16, v183
    v_and_b32 v182, 0xffff0000, v183
    v_add_f32 v179, v179, v181
    v_add_f32 v180, v180, v182
    v_cvt_pk_bf16_f32 v183, v179, v180
    v_lshlrev_b32 v179, 16, v183
    v_and_b32 v180, 0xffff0000, v183
    v_mul_f32 v179, v179, v175
    v_mul_f32 v180, v180, v176
    v_cvt_pk_bf16_f32 v187, v180, v179
    v_mul_f32 v179, v170, v102
    v_mul_f32 v180, v171, v102
    v_cvt_pk_bf16_f32 v183, v179, v180
    v_lshlrev_b32 v179, 16, v183
    v_and_b32 v180, 0xffff0000, v183
    v_mul_f32 v181, v171, v101
    v_mul_f32 v182, v172, v101
    v_cvt_pk_bf16_f32 v183, v181, v182
    v_lshlrev_b32 v181, 16, v183
    v_and_b32 v182, 0xffff0000, v183
    v_add_f32 v179, v179, v181
    v_add_f32 v180, v180, v182
    v_cvt_pk_bf16_f32 v183, v179, v180
    v_lshlrev_b32 v179, 16, v183
    v_and_b32 v180, 0xffff0000, v183
    v_mul_f32 v181, v172, v100
    v_mul_f32 v182, v173, v100
    v_cvt_pk_bf16_f32 v183, v181, v182
    v_lshlrev_b32 v181, 16, v183
    v_and_b32 v182, 0xffff0000, v183
    v_add_f32 v179, v179, v181
    v_add_f32 v180, v180, v182
    v_cvt_pk_bf16_f32 v183, v179, v180
    v_lshlrev_b32 v179, 16, v183
    v_and_b32 v180, 0xffff0000, v183
    v_mul_f32 v181, v173, v99
    v_mul_f32 v182, v174, v99
    v_cvt_pk_bf16_f32 v183, v181, v182
    v_lshlrev_b32 v181, 16, v183
    v_and_b32 v182, 0xffff0000, v183
    v_add_f32 v179, v179, v181
    v_add_f32 v180, v180, v182
    v_cvt_pk_bf16_f32 v183, v179, v180
    v_lshlrev_b32 v179, 16, v183
    v_and_b32 v180, 0xffff0000, v183
    v_mul_f32 v179, v179, v177
    v_mul_f32 v180, v180, v178
    v_cvt_pk_bf16_f32 v186, v180, v179
    s_mov_b32 s84, 4096
    buffer_store_dwordx2 v[186:187], v98, s[72:75], s84 offen sc1
    v_lshlrev_b32 v99, 16, v112
    v_and_b32 v100, 0xffff0000, v112
    v_lshlrev_b32 v101, 16, v113
    v_and_b32 v102, 0xffff0000, v113
    v_lshlrev_b32 v168, 16, v125
    v_lshlrev_b32 v169, 16, v129
    v_lshlrev_b32 v170, 16, v133
    v_lshlrev_b32 v171, 16, v137
    v_lshlrev_b32 v172, 16, v141
    v_lshlrev_b32 v173, 16, v145
    v_lshlrev_b32 v174, 16, v149
    v_lshlrev_b32 v175, 16, v153
    v_lshlrev_b32 v176, 16, v157
    v_lshlrev_b32 v177, 16, v161
    v_lshlrev_b32 v178, 16, v165
    v_mul_f32 v179, v168, v102
    v_mul_f32 v180, v169, v102
    v_cvt_pk_bf16_f32 v183, v179, v180
    v_lshlrev_b32 v179, 16, v183
    v_and_b32 v180, 0xffff0000, v183
    v_mul_f32 v181, v169, v101
    v_mul_f32 v182, v170, v101
    v_cvt_pk_bf16_f32 v183, v181, v182
    v_lshlrev_b32 v181, 16, v183
    v_and_b32 v182, 0xffff0000, v183
    v_add_f32 v179, v179, v181
    v_add_f32 v180, v180, v182
    v_cvt_pk_bf16_f32 v183, v179, v180
    v_lshlrev_b32 v179, 16, v183
    v_and_b32 v180, 0xffff0000, v183
    v_mul_f32 v181, v170, v100
    v_mul_f32 v182, v171, v100
    v_cvt_pk_bf16_f32 v183, v181, v182
    v_lshlrev_b32 v181, 16, v183
    v_and_b32 v182, 0xffff0000, v183
    v_add_f32 v179, v179, v181
    v_add_f32 v180, v180, v182
    v_cvt_pk_bf16_f32 v183, v179, v180
    v_lshlrev_b32 v179, 16, v183
    v_and_b32 v180, 0xffff0000, v183
    v_mul_f32 v181, v171, v99
    v_mul_f32 v182, v172, v99
    v_cvt_pk_bf16_f32 v183, v181, v182
    v_lshlrev_b32 v181, 16, v183
    v_and_b32 v182, 0xffff0000, v183
    v_add_f32 v179, v179, v181
    v_add_f32 v180, v180, v182
    v_cvt_pk_bf16_f32 v183, v179, v180
    v_lshlrev_b32 v179, 16, v183
    v_and_b32 v180, 0xffff0000, v183
    v_mul_f32 v179, v179, v175
    v_mul_f32 v180, v180, v176
    v_cvt_pk_bf16_f32 v185, v180, v179
    v_mul_f32 v179, v170, v102
    v_mul_f32 v180, v171, v102
    v_cvt_pk_bf16_f32 v183, v179, v180
    v_lshlrev_b32 v179, 16, v183
    v_and_b32 v180, 0xffff0000, v183
    v_mul_f32 v181, v171, v101
    v_mul_f32 v182, v172, v101
    v_cvt_pk_bf16_f32 v183, v181, v182
    v_lshlrev_b32 v181, 16, v183
    v_and_b32 v182, 0xffff0000, v183
    v_add_f32 v179, v179, v181
    v_add_f32 v180, v180, v182
    v_cvt_pk_bf16_f32 v183, v179, v180
    v_lshlrev_b32 v179, 16, v183
    v_and_b32 v180, 0xffff0000, v183
    v_mul_f32 v181, v172, v100
    v_mul_f32 v182, v173, v100
    v_cvt_pk_bf16_f32 v183, v181, v182
    v_lshlrev_b32 v181, 16, v183
    v_and_b32 v182, 0xffff0000, v183
    v_add_f32 v179, v179, v181
    v_add_f32 v180, v180, v182
    v_cvt_pk_bf16_f32 v183, v179, v180
    v_lshlrev_b32 v179, 16, v183
    v_and_b32 v180, 0xffff0000, v183
    v_mul_f32 v181, v173, v99
    v_mul_f32 v182, v174, v99
    v_cvt_pk_bf16_f32 v183, v181, v182
    v_lshlrev_b32 v181, 16, v183
    v_and_b32 v182, 0xffff0000, v183
    v_add_f32 v179, v179, v181
    v_add_f32 v180, v180, v182
    v_cvt_pk_bf16_f32 v183, v179, v180
    v_lshlrev_b32 v179, 16, v183
    v_and_b32 v180, 0xffff0000, v183
    v_mul_f32 v179, v179, v177
    v_mul_f32 v180, v180, v178
    v_cvt_pk_bf16_f32 v184, v180, v179
    s_mov_b32 s84, 8192
    buffer_store_dwordx2 v[184:185], v98, s[72:75], s84 offen sc1
    v_lshlrev_b32 v99, 16, v114
    v_and_b32 v100, 0xffff0000, v114
    v_lshlrev_b32 v101, 16, v115
    v_and_b32 v102, 0xffff0000, v115
    v_and_b32 v168, 0xffff0000, v125
    v_and_b32 v169, 0xffff0000, v129
    v_and_b32 v170, 0xffff0000, v133
    v_and_b32 v171, 0xffff0000, v137
    v_and_b32 v172, 0xffff0000, v141
    v_and_b32 v173, 0xffff0000, v145
    v_and_b32 v174, 0xffff0000, v149
    v_and_b32 v175, 0xffff0000, v153
    v_and_b32 v176, 0xffff0000, v157
    v_and_b32 v177, 0xffff0000, v161
    v_and_b32 v178, 0xffff0000, v165
    v_mul_f32 v179, v168, v102
    v_mul_f32 v180, v169, v102
    v_cvt_pk_bf16_f32 v183, v179, v180
    v_lshlrev_b32 v179, 16, v183
    v_and_b32 v180, 0xffff0000, v183
    v_mul_f32 v181, v169, v101
    v_mul_f32 v182, v170, v101
    v_cvt_pk_bf16_f32 v183, v181, v182
    v_lshlrev_b32 v181, 16, v183
    v_and_b32 v182, 0xffff0000, v183
    v_add_f32 v179, v179, v181
    v_add_f32 v180, v180, v182
    v_cvt_pk_bf16_f32 v183, v179, v180
    v_lshlrev_b32 v179, 16, v183
    v_and_b32 v180, 0xffff0000, v183
    v_mul_f32 v181, v170, v100
    v_mul_f32 v182, v171, v100
    v_cvt_pk_bf16_f32 v183, v181, v182
    v_lshlrev_b32 v181, 16, v183
    v_and_b32 v182, 0xffff0000, v183
    v_add_f32 v179, v179, v181
    v_add_f32 v180, v180, v182
    v_cvt_pk_bf16_f32 v183, v179, v180
    v_lshlrev_b32 v179, 16, v183
    v_and_b32 v180, 0xffff0000, v183
    v_mul_f32 v181, v171, v99
    v_mul_f32 v182, v172, v99
    v_cvt_pk_bf16_f32 v183, v181, v182
    v_lshlrev_b32 v181, 16, v183
    v_and_b32 v182, 0xffff0000, v183
    v_add_f32 v179, v179, v181
    v_add_f32 v180, v180, v182
    v_cvt_pk_bf16_f32 v183, v179, v180
    v_lshlrev_b32 v179, 16, v183
    v_and_b32 v180, 0xffff0000, v183
    v_mul_f32 v179, v179, v175
    v_mul_f32 v180, v180, v176
    v_cvt_pk_bf16_f32 v187, v180, v179
    v_mul_f32 v179, v170, v102
    v_mul_f32 v180, v171, v102
    v_cvt_pk_bf16_f32 v183, v179, v180
    v_lshlrev_b32 v179, 16, v183
    v_and_b32 v180, 0xffff0000, v183
    v_mul_f32 v181, v171, v101
    v_mul_f32 v182, v172, v101
    v_cvt_pk_bf16_f32 v183, v181, v182
    v_lshlrev_b32 v181, 16, v183
    v_and_b32 v182, 0xffff0000, v183
    v_add_f32 v179, v179, v181
    v_add_f32 v180, v180, v182
    v_cvt_pk_bf16_f32 v183, v179, v180
    v_lshlrev_b32 v179, 16, v183
    v_and_b32 v180, 0xffff0000, v183
    v_mul_f32 v181, v172, v100
    v_mul_f32 v182, v173, v100
    v_cvt_pk_bf16_f32 v183, v181, v182
    v_lshlrev_b32 v181, 16, v183
    v_and_b32 v182, 0xffff0000, v183
    v_add_f32 v179, v179, v181
    v_add_f32 v180, v180, v182
    v_cvt_pk_bf16_f32 v183, v179, v180
    v_lshlrev_b32 v179, 16, v183
    v_and_b32 v180, 0xffff0000, v183
    v_mul_f32 v181, v173, v99
    v_mul_f32 v182, v174, v99
    v_cvt_pk_bf16_f32 v183, v181, v182
    v_lshlrev_b32 v181, 16, v183
    v_and_b32 v182, 0xffff0000, v183
    v_add_f32 v179, v179, v181
    v_add_f32 v180, v180, v182
    v_cvt_pk_bf16_f32 v183, v179, v180
    v_lshlrev_b32 v179, 16, v183
    v_and_b32 v180, 0xffff0000, v183
    v_mul_f32 v179, v179, v177
    v_mul_f32 v180, v180, v178
    v_cvt_pk_bf16_f32 v186, v180, v179
    s_mov_b32 s84, 12288
    buffer_store_dwordx2 v[186:187], v98, s[72:75], s84 offen sc1
    v_lshlrev_b32 v99, 16, v116
    v_and_b32 v100, 0xffff0000, v116
    v_lshlrev_b32 v101, 16, v117
    v_and_b32 v102, 0xffff0000, v117
    v_lshlrev_b32 v168, 16, v126
    v_lshlrev_b32 v169, 16, v130
    v_lshlrev_b32 v170, 16, v134
    v_lshlrev_b32 v171, 16, v138
    v_lshlrev_b32 v172, 16, v142
    v_lshlrev_b32 v173, 16, v146
    v_lshlrev_b32 v174, 16, v150
    v_lshlrev_b32 v175, 16, v154
    v_lshlrev_b32 v176, 16, v158
    v_lshlrev_b32 v177, 16, v162
    v_lshlrev_b32 v178, 16, v166
    v_mul_f32 v179, v168, v102
    v_mul_f32 v180, v169, v102
    v_cvt_pk_bf16_f32 v183, v179, v180
    v_lshlrev_b32 v179, 16, v183
    v_and_b32 v180, 0xffff0000, v183
    v_mul_f32 v181, v169, v101
    v_mul_f32 v182, v170, v101
    v_cvt_pk_bf16_f32 v183, v181, v182
    v_lshlrev_b32 v181, 16, v183
    v_and_b32 v182, 0xffff0000, v183
    v_add_f32 v179, v179, v181
    v_add_f32 v180, v180, v182
    v_cvt_pk_bf16_f32 v183, v179, v180
    v_lshlrev_b32 v179, 16, v183
    v_and_b32 v180, 0xffff0000, v183
    v_mul_f32 v181, v170, v100
    v_mul_f32 v182, v171, v100
    v_cvt_pk_bf16_f32 v183, v181, v182
    v_lshlrev_b32 v181, 16, v183
    v_and_b32 v182, 0xffff0000, v183
    v_add_f32 v179, v179, v181
    v_add_f32 v180, v180, v182
    v_cvt_pk_bf16_f32 v183, v179, v180
    v_lshlrev_b32 v179, 16, v183
    v_and_b32 v180, 0xffff0000, v183
    v_mul_f32 v181, v171, v99
    v_mul_f32 v182, v172, v99
    v_cvt_pk_bf16_f32 v183, v181, v182
    v_lshlrev_b32 v181, 16, v183
    v_and_b32 v182, 0xffff0000, v183
    v_add_f32 v179, v179, v181
    v_add_f32 v180, v180, v182
    v_cvt_pk_bf16_f32 v183, v179, v180
    v_lshlrev_b32 v179, 16, v183
    v_and_b32 v180, 0xffff0000, v183
    v_mul_f32 v179, v179, v175
    v_mul_f32 v180, v180, v176
    v_cvt_pk_bf16_f32 v185, v180, v179
    v_mul_f32 v179, v170, v102
    v_mul_f32 v180, v171, v102
    v_cvt_pk_bf16_f32 v183, v179, v180
    v_lshlrev_b32 v179, 16, v183
    v_and_b32 v180, 0xffff0000, v183
    v_mul_f32 v181, v171, v101
    v_mul_f32 v182, v172, v101
    v_cvt_pk_bf16_f32 v183, v181, v182
    v_lshlrev_b32 v181, 16, v183
    v_and_b32 v182, 0xffff0000, v183
    v_add_f32 v179, v179, v181
    v_add_f32 v180, v180, v182
    v_cvt_pk_bf16_f32 v183, v179, v180
    v_lshlrev_b32 v179, 16, v183
    v_and_b32 v180, 0xffff0000, v183
    v_mul_f32 v181, v172, v100
    v_mul_f32 v182, v173, v100
    v_cvt_pk_bf16_f32 v183, v181, v182
    v_lshlrev_b32 v181, 16, v183
    v_and_b32 v182, 0xffff0000, v183
    v_add_f32 v179, v179, v181
    v_add_f32 v180, v180, v182
    v_cvt_pk_bf16_f32 v183, v179, v180
    v_lshlrev_b32 v179, 16, v183
    v_and_b32 v180, 0xffff0000, v183
    v_mul_f32 v181, v173, v99
    v_mul_f32 v182, v174, v99
    v_cvt_pk_bf16_f32 v183, v181, v182
    v_lshlrev_b32 v181, 16, v183
    v_and_b32 v182, 0xffff0000, v183
    v_add_f32 v179, v179, v181
    v_add_f32 v180, v180, v182
    v_cvt_pk_bf16_f32 v183, v179, v180
    v_lshlrev_b32 v179, 16, v183
    v_and_b32 v180, 0xffff0000, v183
    v_mul_f32 v179, v179, v177
    v_mul_f32 v180, v180, v178
    v_cvt_pk_bf16_f32 v184, v180, v179
    s_mov_b32 s84, 16384
    buffer_store_dwordx2 v[184:185], v98, s[72:75], s84 offen sc1
    v_lshlrev_b32 v99, 16, v118
    v_and_b32 v100, 0xffff0000, v118
    v_lshlrev_b32 v101, 16, v119
    v_and_b32 v102, 0xffff0000, v119
    v_and_b32 v168, 0xffff0000, v126
    v_and_b32 v169, 0xffff0000, v130
    v_and_b32 v170, 0xffff0000, v134
    v_and_b32 v171, 0xffff0000, v138
    v_and_b32 v172, 0xffff0000, v142
    v_and_b32 v173, 0xffff0000, v146
    v_and_b32 v174, 0xffff0000, v150
    v_and_b32 v175, 0xffff0000, v154
    v_and_b32 v176, 0xffff0000, v158
    v_and_b32 v177, 0xffff0000, v162
    v_and_b32 v178, 0xffff0000, v166
    v_mul_f32 v179, v168, v102
    v_mul_f32 v180, v169, v102
    v_cvt_pk_bf16_f32 v183, v179, v180
    v_lshlrev_b32 v179, 16, v183
    v_and_b32 v180, 0xffff0000, v183
    v_mul_f32 v181, v169, v101
    v_mul_f32 v182, v170, v101
    v_cvt_pk_bf16_f32 v183, v181, v182
    v_lshlrev_b32 v181, 16, v183
    v_and_b32 v182, 0xffff0000, v183
    v_add_f32 v179, v179, v181
    v_add_f32 v180, v180, v182
    v_cvt_pk_bf16_f32 v183, v179, v180
    v_lshlrev_b32 v179, 16, v183
    v_and_b32 v180, 0xffff0000, v183
    v_mul_f32 v181, v170, v100
    v_mul_f32 v182, v171, v100
    v_cvt_pk_bf16_f32 v183, v181, v182
    v_lshlrev_b32 v181, 16, v183
    v_and_b32 v182, 0xffff0000, v183
    v_add_f32 v179, v179, v181
    v_add_f32 v180, v180, v182
    v_cvt_pk_bf16_f32 v183, v179, v180
    v_lshlrev_b32 v179, 16, v183
    v_and_b32 v180, 0xffff0000, v183
    v_mul_f32 v181, v171, v99
    v_mul_f32 v182, v172, v99
    v_cvt_pk_bf16_f32 v183, v181, v182
    v_lshlrev_b32 v181, 16, v183
    v_and_b32 v182, 0xffff0000, v183
    v_add_f32 v179, v179, v181
    v_add_f32 v180, v180, v182
    v_cvt_pk_bf16_f32 v183, v179, v180
    v_lshlrev_b32 v179, 16, v183
    v_and_b32 v180, 0xffff0000, v183
    v_mul_f32 v179, v179, v175
    v_mul_f32 v180, v180, v176
    v_cvt_pk_bf16_f32 v187, v180, v179
    v_mul_f32 v179, v170, v102
    v_mul_f32 v180, v171, v102
    v_cvt_pk_bf16_f32 v183, v179, v180
    v_lshlrev_b32 v179, 16, v183
    v_and_b32 v180, 0xffff0000, v183
    v_mul_f32 v181, v171, v101
    v_mul_f32 v182, v172, v101
    v_cvt_pk_bf16_f32 v183, v181, v182
    v_lshlrev_b32 v181, 16, v183
    v_and_b32 v182, 0xffff0000, v183
    v_add_f32 v179, v179, v181
    v_add_f32 v180, v180, v182
    v_cvt_pk_bf16_f32 v183, v179, v180
    v_lshlrev_b32 v179, 16, v183
    v_and_b32 v180, 0xffff0000, v183
    v_mul_f32 v181, v172, v100
    v_mul_f32 v182, v173, v100
    v_cvt_pk_bf16_f32 v183, v181, v182
    v_lshlrev_b32 v181, 16, v183
    v_and_b32 v182, 0xffff0000, v183
    v_add_f32 v179, v179, v181
    v_add_f32 v180, v180, v182
    v_cvt_pk_bf16_f32 v183, v179, v180
    v_lshlrev_b32 v179, 16, v183
    v_and_b32 v180, 0xffff0000, v183
    v_mul_f32 v181, v173, v99
    v_mul_f32 v182, v174, v99
    v_cvt_pk_bf16_f32 v183, v181, v182
    v_lshlrev_b32 v181, 16, v183
    v_and_b32 v182, 0xffff0000, v183
    v_add_f32 v179, v179, v181
    v_add_f32 v180, v180, v182
    v_cvt_pk_bf16_f32 v183, v179, v180
    v_lshlrev_b32 v179, 16, v183
    v_and_b32 v180, 0xffff0000, v183
    v_mul_f32 v179, v179, v177
    v_mul_f32 v180, v180, v178
    v_cvt_pk_bf16_f32 v186, v180, v179
    s_mov_b32 s84, 20480
    buffer_store_dwordx2 v[186:187], v98, s[72:75], s84 offen sc1
    v_lshlrev_b32 v99, 16, v120
    v_and_b32 v100, 0xffff0000, v120
    v_lshlrev_b32 v101, 16, v121
    v_and_b32 v102, 0xffff0000, v121
    v_lshlrev_b32 v168, 16, v127
    v_lshlrev_b32 v169, 16, v131
    v_lshlrev_b32 v170, 16, v135
    v_lshlrev_b32 v171, 16, v139
    v_lshlrev_b32 v172, 16, v143
    v_lshlrev_b32 v173, 16, v147
    v_lshlrev_b32 v174, 16, v151
    v_lshlrev_b32 v175, 16, v155
    v_lshlrev_b32 v176, 16, v159
    v_lshlrev_b32 v177, 16, v163
    v_lshlrev_b32 v178, 16, v167
    v_mul_f32 v179, v168, v102
    v_mul_f32 v180, v169, v102
    v_cvt_pk_bf16_f32 v183, v179, v180
    v_lshlrev_b32 v179, 16, v183
    v_and_b32 v180, 0xffff0000, v183
    v_mul_f32 v181, v169, v101
    v_mul_f32 v182, v170, v101
    v_cvt_pk_bf16_f32 v183, v181, v182
    v_lshlrev_b32 v181, 16, v183
    v_and_b32 v182, 0xffff0000, v183
    v_add_f32 v179, v179, v181
    v_add_f32 v180, v180, v182
    v_cvt_pk_bf16_f32 v183, v179, v180
    v_lshlrev_b32 v179, 16, v183
    v_and_b32 v180, 0xffff0000, v183
    v_mul_f32 v181, v170, v100
    v_mul_f32 v182, v171, v100
    v_cvt_pk_bf16_f32 v183, v181, v182
    v_lshlrev_b32 v181, 16, v183
    v_and_b32 v182, 0xffff0000, v183
    v_add_f32 v179, v179, v181
    v_add_f32 v180, v180, v182
    v_cvt_pk_bf16_f32 v183, v179, v180
    v_lshlrev_b32 v179, 16, v183
    v_and_b32 v180, 0xffff0000, v183
    v_mul_f32 v181, v171, v99
    v_mul_f32 v182, v172, v99
    v_cvt_pk_bf16_f32 v183, v181, v182
    v_lshlrev_b32 v181, 16, v183
    v_and_b32 v182, 0xffff0000, v183
    v_add_f32 v179, v179, v181
    v_add_f32 v180, v180, v182
    v_cvt_pk_bf16_f32 v183, v179, v180
    v_lshlrev_b32 v179, 16, v183
    v_and_b32 v180, 0xffff0000, v183
    v_mul_f32 v179, v179, v175
    v_mul_f32 v180, v180, v176
    v_cvt_pk_bf16_f32 v185, v180, v179
    v_mul_f32 v179, v170, v102
    v_mul_f32 v180, v171, v102
    v_cvt_pk_bf16_f32 v183, v179, v180
    v_lshlrev_b32 v179, 16, v183
    v_and_b32 v180, 0xffff0000, v183
    v_mul_f32 v181, v171, v101
    v_mul_f32 v182, v172, v101
    v_cvt_pk_bf16_f32 v183, v181, v182
    v_lshlrev_b32 v181, 16, v183
    v_and_b32 v182, 0xffff0000, v183
    v_add_f32 v179, v179, v181
    v_add_f32 v180, v180, v182
    v_cvt_pk_bf16_f32 v183, v179, v180
    v_lshlrev_b32 v179, 16, v183
    v_and_b32 v180, 0xffff0000, v183
    v_mul_f32 v181, v172, v100
    v_mul_f32 v182, v173, v100
    v_cvt_pk_bf16_f32 v183, v181, v182
    v_lshlrev_b32 v181, 16, v183
    v_and_b32 v182, 0xffff0000, v183
    v_add_f32 v179, v179, v181
    v_add_f32 v180, v180, v182
    v_cvt_pk_bf16_f32 v183, v179, v180
    v_lshlrev_b32 v179, 16, v183
    v_and_b32 v180, 0xffff0000, v183
    v_mul_f32 v181, v173, v99
    v_mul_f32 v182, v174, v99
    v_cvt_pk_bf16_f32 v183, v181, v182
    v_lshlrev_b32 v181, 16, v183
    v_and_b32 v182, 0xffff0000, v183
    v_add_f32 v179, v179, v181
    v_add_f32 v180, v180, v182
    v_cvt_pk_bf16_f32 v183, v179, v180
    v_lshlrev_b32 v179, 16, v183
    v_and_b32 v180, 0xffff0000, v183
    v_mul_f32 v179, v179, v177
    v_mul_f32 v180, v180, v178
    v_cvt_pk_bf16_f32 v184, v180, v179
    s_mov_b32 s84, 24576
    buffer_store_dwordx2 v[184:185], v98, s[72:75], s84 offen sc1
    v_lshlrev_b32 v99, 16, v122
    v_and_b32 v100, 0xffff0000, v122
    v_lshlrev_b32 v101, 16, v123
    v_and_b32 v102, 0xffff0000, v123
    v_and_b32 v168, 0xffff0000, v127
    v_and_b32 v169, 0xffff0000, v131
    v_and_b32 v170, 0xffff0000, v135
    v_and_b32 v171, 0xffff0000, v139
    v_and_b32 v172, 0xffff0000, v143
    v_and_b32 v173, 0xffff0000, v147
    v_and_b32 v174, 0xffff0000, v151
    v_and_b32 v175, 0xffff0000, v155
    v_and_b32 v176, 0xffff0000, v159
    v_and_b32 v177, 0xffff0000, v163
    v_and_b32 v178, 0xffff0000, v167
    v_mul_f32 v179, v168, v102
    v_mul_f32 v180, v169, v102
    v_cvt_pk_bf16_f32 v183, v179, v180
    v_lshlrev_b32 v179, 16, v183
    v_and_b32 v180, 0xffff0000, v183
    v_mul_f32 v181, v169, v101
    v_mul_f32 v182, v170, v101
    v_cvt_pk_bf16_f32 v183, v181, v182
    v_lshlrev_b32 v181, 16, v183
    v_and_b32 v182, 0xffff0000, v183
    v_add_f32 v179, v179, v181
    v_add_f32 v180, v180, v182
    v_cvt_pk_bf16_f32 v183, v179, v180
    v_lshlrev_b32 v179, 16, v183
    v_and_b32 v180, 0xffff0000, v183
    v_mul_f32 v181, v170, v100
    v_mul_f32 v182, v171, v100
    v_cvt_pk_bf16_f32 v183, v181, v182
    v_lshlrev_b32 v181, 16, v183
    v_and_b32 v182, 0xffff0000, v183
    v_add_f32 v179, v179, v181
    v_add_f32 v180, v180, v182
    v_cvt_pk_bf16_f32 v183, v179, v180
    v_lshlrev_b32 v179, 16, v183
    v_and_b32 v180, 0xffff0000, v183
    v_mul_f32 v181, v171, v99
    v_mul_f32 v182, v172, v99
    v_cvt_pk_bf16_f32 v183, v181, v182
    v_lshlrev_b32 v181, 16, v183
    v_and_b32 v182, 0xffff0000, v183
    v_add_f32 v179, v179, v181
    v_add_f32 v180, v180, v182
    v_cvt_pk_bf16_f32 v183, v179, v180
    v_lshlrev_b32 v179, 16, v183
    v_and_b32 v180, 0xffff0000, v183
    v_mul_f32 v179, v179, v175
    v_mul_f32 v180, v180, v176
    v_cvt_pk_bf16_f32 v187, v180, v179
    v_mul_f32 v179, v170, v102
    v_mul_f32 v180, v171, v102
    v_cvt_pk_bf16_f32 v183, v179, v180
    v_lshlrev_b32 v179, 16, v183
    v_and_b32 v180, 0xffff0000, v183
    v_mul_f32 v181, v171, v101
    v_mul_f32 v182, v172, v101
    v_cvt_pk_bf16_f32 v183, v181, v182
    v_lshlrev_b32 v181, 16, v183
    v_and_b32 v182, 0xffff0000, v183
    v_add_f32 v179, v179, v181
    v_add_f32 v180, v180, v182
    v_cvt_pk_bf16_f32 v183, v179, v180
    v_lshlrev_b32 v179, 16, v183
    v_and_b32 v180, 0xffff0000, v183
    v_mul_f32 v181, v172, v100
    v_mul_f32 v182, v173, v100
    v_cvt_pk_bf16_f32 v183, v181, v182
    v_lshlrev_b32 v181, 16, v183
    v_and_b32 v182, 0xffff0000, v183
    v_add_f32 v179, v179, v181
    v_add_f32 v180, v180, v182
    v_cvt_pk_bf16_f32 v183, v179, v180
    v_lshlrev_b32 v179, 16, v183
    v_and_b32 v180, 0xffff0000, v183
    v_mul_f32 v181, v173, v99
    v_mul_f32 v182, v174, v99
    v_cvt_pk_bf16_f32 v183, v181, v182
    v_lshlrev_b32 v181, 16, v183
    v_and_b32 v182, 0xffff0000, v183
    v_add_f32 v179, v179, v181
    v_add_f32 v180, v180, v182
    v_cvt_pk_bf16_f32 v183, v179, v180
    v_lshlrev_b32 v179, 16, v183
    v_and_b32 v180, 0xffff0000, v183
    v_mul_f32 v179, v179, v177
    v_mul_f32 v180, v180, v178
    v_cvt_pk_bf16_f32 v186, v180, v179
    s_mov_b32 s84, 28672
    buffer_store_dwordx2 v[186:187], v98, s[72:75], s84 offen sc1
Lnoap1:
    s_and_b32 s57, s3, 3
    s_mul_i32 s58, s57, 21248
    s_lshl_b32 s59, s2, 2
    s_add_u32 s57, s57, s59
    s_load_dwordx4 s[80:83], s[0:1], 32
    s_load_dwordx2 s[86:87], s[0:1], 96
    s_lshl_b32 s76, s57, 12
    s_waitcnt lgkmcnt(0)
    s_mov_b32 s60, s80
    s_mov_b32 s61, s81
    s_mov_b32 s62, 4194304
    s_mov_b32 s63, 0x00020000
    s_mov_b32 s68, s82
    s_mov_b32 s69, s83
    s_mov_b32 s70, 2048
    s_mov_b32 s71, 0x00020000
    s_mov_b32 s64, s86
    s_mov_b32 s65, s87
    s_mov_b32 s66, 4194304
    s_mov_b32 s67, 0x00020000
    s_add_u32 s72, s86, 4194304
    s_addc_u32 s73, s87, 0
    s_mov_b32 s74, 4194304
    s_mov_b32 s75, 0x00020000
    s_cmp_lg_u32 s3, 0
    s_cbranch_scc1 Low
    s_lshl_b32 s5, s7, 8
    s_add_u32 s5, s5, 0
    v_mov_b32 v54, s5
    s_mov_b32 s99, 0
    Lpoll_s:
    buffer_load_dword v55, v54, s[8:11], 0 offen sc1
    s_waitcnt vmcnt(0)
    v_readfirstlane_b32 s5, v55
    s_nop 3
    s_cmp_ge_u32 s5, 16
    s_cbranch_scc1 Lpoll_s_done
    s_sleep 2
    s_add_u32 s99, s99, 1
    s_cmp_lt_u32 s99, 0x40000
    s_cbranch_scc1 Lpoll_s
    Lpoll_s_done:
    v_mov_b32 v54, 163792
    v_mov_b32 v55, 1
    s_mov_b64 exec, 1
    ds_add_u32 v54, v55
    s_mov_b64 exec, -1
Low:
    s_cmp_ge_u32 s3, 4
    s_cbranch_scc1 Lnohl
    v_lshlrev_b32 v2, 4, v0
    s_add_u32 s77, s76, 0
    buffer_load_dwordx4 v[192:195], v2, s[60:63], s77 offen
    buffer_load_dwordx2 v[196:197], v2, s[60:63], s77 offen offset:16
    s_add_u32 s77, s76, 1024
    buffer_load_dwordx4 v[200:203], v2, s[60:63], s77 offen
    buffer_load_dwordx2 v[204:205], v2, s[60:63], s77 offen offset:16
    s_add_u32 s77, s76, 2048
    buffer_load_dwordx4 v[208:211], v2, s[60:63], s77 offen
    buffer_load_dwordx2 v[212:213], v2, s[60:63], s77 offen offset:16
    s_add_u32 s77, s76, 3072
    buffer_load_dwordx4 v[216:219], v2, s[60:63], s77 offen
    buffer_load_dwordx2 v[220:221], v2, s[60:63], s77 offen offset:16
Lnohl:
    v_mov_b32 v54, 163792
    s_mov_b32 s99, 0
    Lw5:
    ds_read_b32 v55, v54
    s_waitcnt lgkmcnt(0)
    v_readfirstlane_b32 s5, v55
    s_add_u32 s99, s99, 1
    s_cmp_ge_u32 s99, 0x400000
    s_cbranch_scc1 Lw5_done
    s_cmp_lt_u32 s5, 1
    s_cbranch_scc1 Lw5
    Lw5_done:
    s_lshr_b32 s38, s3, 1
    s_mul_i32 s41, s39, 135168
    s_lshl_b32 s5, s38, 11
    s_add_u32 s41, s41, s5
    s_add_u32 s5, s41, 0
    buffer_load_dwordx4 v[64:67], v53, s[24:27], s5 offen offset:0 sc1
    buffer_load_dwordx4 v[68:71], v53, s[24:27], s5 offen offset:1024 sc1
    s_add_u32 s5, s41, 8448
    buffer_load_dwordx4 v[72:75], v53, s[24:27], s5 offen offset:0 sc1
    buffer_load_dwordx4 v[76:79], v53, s[24:27], s5 offen offset:1024 sc1
    s_add_u32 s5, s41, 16896
    buffer_load_dwordx4 v[80:83], v53, s[24:27], s5 offen offset:0 sc1
    buffer_load_dwordx4 v[84:87], v53, s[24:27], s5 offen offset:1024 sc1
    s_add_u32 s5, s41, 25344
    buffer_load_dwordx4 v[88:91], v53, s[24:27], s5 offen offset:0 sc1
    buffer_load_dwordx4 v[92:95], v53, s[24:27], s5 offen offset:1024 sc1
    s_add_u32 s5, s41, 33792
    buffer_load_dwordx4 v[96:99], v53, s[24:27], s5 offen offset:0 sc1
    buffer_load_dwordx4 v[100:103], v53, s[24:27], s5 offen offset:1024 sc1
    s_add_u32 s5, s41, 42240
    buffer_load_dwordx4 v[104:107], v53, s[24:27], s5 offen offset:0 sc1
    buffer_load_dwordx4 v[108:111], v53, s[24:27], s5 offen offset:1024 sc1
    s_add_u32 s5, s41, 50688
    buffer_load_dwordx4 v[112:115], v53, s[24:27], s5 offen offset:0 sc1
    buffer_load_dwordx4 v[116:119], v53, s[24:27], s5 offen offset:1024 sc1
    s_add_u32 s5, s41, 59136
    buffer_load_dwordx4 v[120:123], v53, s[24:27], s5 offen offset:0 sc1
    buffer_load_dwordx4 v[124:127], v53, s[24:27], s5 offen offset:1024 sc1
    s_add_u32 s5, s41, 67584
    buffer_load_dwordx4 v[128:131], v53, s[24:27], s5 offen offset:0 sc1
    buffer_load_dwordx4 v[132:135], v53, s[24:27], s5 offen offset:1024 sc1
    s_add_u32 s5, s41, 76032
    buffer_load_dwordx4 v[136:139], v53, s[24:27], s5 offen offset:0 sc1
    buffer_load_dwordx4 v[140:143], v53, s[24:27], s5 offen offset:1024 sc1
    s_add_u32 s5, s41, 84480
    buffer_load_dwordx4 v[144:147], v53, s[24:27], s5 offen offset:0 sc1
    buffer_load_dwordx4 v[148:151], v53, s[24:27], s5 offen offset:1024 sc1
    s_add_u32 s5, s41, 92928
    buffer_load_dwordx4 v[152:155], v53, s[24:27], s5 offen offset:0 sc1
    buffer_load_dwordx4 v[156:159], v53, s[24:27], s5 offen offset:1024 sc1
    s_add_u32 s5, s41, 101376
    buffer_load_dwordx4 v[160:163], v53, s[24:27], s5 offen offset:0 sc1
    buffer_load_dwordx4 v[164:167], v53, s[24:27], s5 offen offset:1024 sc1
    s_add_u32 s5, s41, 109824
    buffer_load_dwordx4 v[168:171], v53, s[24:27], s5 offen offset:0 sc1
    buffer_load_dwordx4 v[172:175], v53, s[24:27], s5 offen offset:1024 sc1
    s_add_u32 s5, s41, 118272
    buffer_load_dwordx4 v[176:179], v53, s[24:27], s5 offen offset:0 sc1
    buffer_load_dwordx4 v[180:183], v53, s[24:27], s5 offen offset:1024 sc1
    s_add_u32 s5, s41, 126720
    buffer_load_dwordx4 v[184:187], v53, s[24:27], s5 offen offset:0 sc1
    buffer_load_dwordx4 v[188:191], v53, s[24:27], s5 offen offset:1024 sc1
    s_cmp_lg_u32 s38, 0
    s_cbranch_scc1 Lnozl0
    v_lshrrev_b32 v40, 4, v0
    s_mov_b32 s5, 8448
    v_mul_lo_u32 v40, v40, s5
    v_and_b32 v41, 15, v0
    v_lshl_add_u32 v40, v41, 4, v40
    s_mul_i32 s41, s39, 135168
    s_add_u32 s5, s41, 8192
    buffer_load_dwordx4 v[24:27], v40, s[24:27], s5 offen sc1
    s_add_u32 s5, s41, 41984
    buffer_load_dwordx4 v[28:31], v40, s[24:27], s5 offen sc1
    s_add_u32 s5, s41, 75776
    buffer_load_dwordx4 v[32:35], v40, s[24:27], s5 offen sc1
    s_add_u32 s5, s41, 109568
    buffer_load_dwordx4 v[36:39], v40, s[24:27], s5 offen sc1
Lnozl0:
    s_cmp_ge_u32 s3, 4
    s_cbranch_scc1 Lnohb
    v_mov_b32 v12, 0
    v_mov_b32 v13, 0
    v_mov_b32 v14, 0
    v_mov_b32 v15, 0
    v_add_u32 v16, s58, v2
    v_cmp_gt_u32 vcc, 32, v0
    s_and_saveexec_b64 s[78:79], vcc
    ds_write_b128 v16, v[12:15] offset:20736
    v_cmp_gt_u32 vcc, 1, v0
    s_and_b64 exec, exec, vcc
    ds_write_b128 v16, v[12:15] offset:0
    ds_write_b64 v16, v[12:13] offset:16
    ds_write_b128 v16, v[12:15] offset:4160
    ds_write_b64 v16, v[12:13] offset:4176
    ds_write_b128 v16, v[12:15] offset:8320
    ds_write_b64 v16, v[12:13] offset:8336
    ds_write_b128 v16, v[12:15] offset:12480
    ds_write_b64 v16, v[12:13] offset:12496
    s_waitcnt vmcnt(39)
    ds_write_b64 v16, v[12:13] offset:24
    v_mov_b32 v4, 0
    v_lshlrev_b32 v5, 16, v192
    ds_write_b64 v16, v[4:5] offset:4184
    v_mov_b32 v5, v192
    ds_write_b64 v16, v[4:5] offset:8344
    v_lshlrev_b32 v4, 16, v192
    v_alignbyte_b32 v5, v193, v192, 2
    ds_write_b64 v16, v[4:5] offset:12504
    s_mov_b64 exec, s[78:79]
    s_waitcnt vmcnt(38)
    ds_write_b128 v16, v[192:195] offset:32
    v_alignbyte_b32 v4, v193, v192, 2
    v_alignbyte_b32 v5, v194, v193, 2
    v_alignbyte_b32 v6, v195, v194, 2
    v_alignbyte_b32 v7, v196, v195, 2
    ds_write_b128 v16, v[4:7] offset:4192
    v_mov_b32 v8, v193
    v_mov_b32 v9, v194
    v_mov_b32 v10, v195
    v_mov_b32 v11, v196
    ds_write_b128 v16, v[8:11] offset:8352
    v_alignbyte_b32 v12, v194, v193, 2
    v_alignbyte_b32 v13, v195, v194, 2
    v_alignbyte_b32 v14, v196, v195, 2
    v_alignbyte_b32 v15, v197, v196, 2
    ds_write_b128 v16, v[12:15] offset:12512
    s_nop 1
    s_waitcnt vmcnt(36)
    ds_write_b128 v16, v[200:203] offset:1056
    v_alignbyte_b32 v4, v201, v200, 2
    v_alignbyte_b32 v5, v202, v201, 2
    v_alignbyte_b32 v6, v203, v202, 2
    v_alignbyte_b32 v7, v204, v203, 2
    ds_write_b128 v16, v[4:7] offset:5216
    v_mov_b32 v8, v201
    v_mov_b32 v9, v202
    v_mov_b32 v10, v203
    v_mov_b32 v11, v204
    ds_write_b128 v16, v[8:11] offset:9376
    v_alignbyte_b32 v12, v202, v201, 2
    v_alignbyte_b32 v13, v203, v202, 2
    v_alignbyte_b32 v14, v204, v203, 2
    v_alignbyte_b32 v15, v205, v204, 2
    ds_write_b128 v16, v[12:15] offset:13536
    s_nop 1
    s_waitcnt vmcnt(34)
    ds_write_b128 v16, v[208:211] offset:2080
    v_alignbyte_b32 v4, v209, v208, 2
    v_alignbyte_b32 v5, v210, v209, 2
    v_alignbyte_b32 v6, v211, v210, 2
    v_alignbyte_b32 v7, v212, v211, 2
    ds_write_b128 v16, v[4:7] offset:6240
    v_mov_b32 v8, v209
    v_mov_b32 v9, v210
    v_mov_b32 v10, v211
    v_mov_b32 v11, v212
    ds_write_b128 v16, v[8:11] offset:10400
    v_alignbyte_b32 v12, v210, v209, 2
    v_alignbyte_b32 v13, v211, v210, 2
    v_alignbyte_b32 v14, v212, v211, 2
    v_alignbyte_b32 v15, v213, v212, 2
    ds_write_b128 v16, v[12:15] offset:14560
    s_nop 1
    s_waitcnt vmcnt(32)
    ds_write_b128 v16, v[216:219] offset:3104
    v_alignbyte_b32 v4, v217, v216, 2
    v_alignbyte_b32 v5, v218, v217, 2
    v_alignbyte_b32 v6, v219, v218, 2
    v_alignbyte_b32 v7, v220, v219, 2
    ds_write_b128 v16, v[4:7] offset:7264
    v_mov_b32 v8, v217
    v_mov_b32 v9, v218
    v_mov_b32 v10, v219
    v_mov_b32 v11, v220
    ds_write_b128 v16, v[8:11] offset:11424
    v_alignbyte_b32 v12, v218, v217, 2
    v_alignbyte_b32 v13, v219, v218, 2
    v_alignbyte_b32 v14, v220, v219, 2
    v_alignbyte_b32 v15, v221, v220, 2
    ds_write_b128 v16, v[12:15] offset:15584
    s_nop 1
Lnohb:
    s_waitcnt vmcnt(28)
    v_add_f32 v64, v64, v72
    v_add_f32 v65, v65, v73
    v_add_f32 v66, v66, v74
    v_add_f32 v67, v67, v75
    v_add_f32 v68, v68, v76
    v_add_f32 v69, v69, v77
    v_add_f32 v70, v70, v78
    v_add_f32 v71, v71, v79
    s_waitcnt vmcnt(26)
    v_add_f32 v64, v64, v80
    v_add_f32 v65, v65, v81
    v_add_f32 v66, v66, v82
    v_add_f32 v67, v67, v83
    v_add_f32 v68, v68, v84
    v_add_f32 v69, v69, v85
    v_add_f32 v70, v70, v86
    v_add_f32 v71, v71, v87
    s_waitcnt vmcnt(24)
    v_add_f32 v64, v64, v88
    v_add_f32 v65, v65, v89
    v_add_f32 v66, v66, v90
    v_add_f32 v67, v67, v91
    v_add_f32 v68, v68, v92
    v_add_f32 v69, v69, v93
    v_add_f32 v70, v70, v94
    v_add_f32 v71, v71, v95
    s_waitcnt vmcnt(22)
    v_add_f32 v64, v64, v96
    v_add_f32 v65, v65, v97
    v_add_f32 v66, v66, v98
    v_add_f32 v67, v67, v99
    v_add_f32 v68, v68, v100
    v_add_f32 v69, v69, v101
    v_add_f32 v70, v70, v102
    v_add_f32 v71, v71, v103
    s_waitcnt vmcnt(20)
    v_add_f32 v64, v64, v104
    v_add_f32 v65, v65, v105
    v_add_f32 v66, v66, v106
    v_add_f32 v67, v67, v107
    v_add_f32 v68, v68, v108
    v_add_f32 v69, v69, v109
    v_add_f32 v70, v70, v110
    v_add_f32 v71, v71, v111
    s_waitcnt vmcnt(18)
    v_add_f32 v64, v64, v112
    v_add_f32 v65, v65, v113
    v_add_f32 v66, v66, v114
    v_add_f32 v67, v67, v115
    v_add_f32 v68, v68, v116
    v_add_f32 v69, v69, v117
    v_add_f32 v70, v70, v118
    v_add_f32 v71, v71, v119
    s_waitcnt vmcnt(16)
    v_add_f32 v64, v64, v120
    v_add_f32 v65, v65, v121
    v_add_f32 v66, v66, v122
    v_add_f32 v67, v67, v123
    v_add_f32 v68, v68, v124
    v_add_f32 v69, v69, v125
    v_add_f32 v70, v70, v126
    v_add_f32 v71, v71, v127
    s_waitcnt vmcnt(14)
    v_add_f32 v64, v64, v128
    v_add_f32 v65, v65, v129
    v_add_f32 v66, v66, v130
    v_add_f32 v67, v67, v131
    v_add_f32 v68, v68, v132
    v_add_f32 v69, v69, v133
    v_add_f32 v70, v70, v134
    v_add_f32 v71, v71, v135
    s_waitcnt vmcnt(12)
    v_add_f32 v64, v64, v136
    v_add_f32 v65, v65, v137
    v_add_f32 v66, v66, v138
    v_add_f32 v67, v67, v139
    v_add_f32 v68, v68, v140
    v_add_f32 v69, v69, v141
    v_add_f32 v70, v70, v142
    v_add_f32 v71, v71, v143
    s_waitcnt vmcnt(10)
    v_add_f32 v64, v64, v144
    v_add_f32 v65, v65, v145
    v_add_f32 v66, v66, v146
    v_add_f32 v67, v67, v147
    v_add_f32 v68, v68, v148
    v_add_f32 v69, v69, v149
    v_add_f32 v70, v70, v150
    v_add_f32 v71, v71, v151
    s_waitcnt vmcnt(8)
    v_add_f32 v64, v64, v152
    v_add_f32 v65, v65, v153
    v_add_f32 v66, v66, v154
    v_add_f32 v67, v67, v155
    v_add_f32 v68, v68, v156
    v_add_f32 v69, v69, v157
    v_add_f32 v70, v70, v158
    v_add_f32 v71, v71, v159
    s_waitcnt vmcnt(6)
    v_add_f32 v64, v64, v160
    v_add_f32 v65, v65, v161
    v_add_f32 v66, v66, v162
    v_add_f32 v67, v67, v163
    v_add_f32 v68, v68, v164
    v_add_f32 v69, v69, v165
    v_add_f32 v70, v70, v166
    v_add_f32 v71, v71, v167
    s_waitcnt vmcnt(4)
    v_add_f32 v64, v64, v168
    v_add_f32 v65, v65, v169
    v_add_f32 v66, v66, v170
    v_add_f32 v67, v67, v171
    v_add_f32 v68, v68, v172
    v_add_f32 v69, v69, v173
    v_add_f32 v70, v70, v174
    v_add_f32 v71, v71, v175
    s_waitcnt vmcnt(2)
    v_add_f32 v64, v64, v176
    v_add_f32 v65, v65, v177
    v_add_f32 v66, v66, v178
    v_add_f32 v67, v67, v179
    v_add_f32 v68, v68, v180
    v_add_f32 v69, v69, v181
    v_add_f32 v70, v70, v182
    v_add_f32 v71, v71, v183
    s_waitcnt vmcnt(0)
    v_add_f32 v64, v64, v184
    v_add_f32 v65, v65, v185
    v_add_f32 v66, v66, v186
    v_add_f32 v67, v67, v187
    v_add_f32 v68, v68, v188
    v_add_f32 v69, v69, v189
    v_add_f32 v70, v70, v190
    v_add_f32 v71, v71, v191
    v_cvt_pk_bf16_f32 v72, v64, v65
    v_cvt_pk_bf16_f32 v73, v66, v67
    v_cvt_pk_bf16_f32 v74, v68, v69
    v_cvt_pk_bf16_f32 v75, v70, v71
    s_and_b32 s5, s3, 1
    s_mul_i32 s5, s5, 4352
    s_add_u32 s5, s5, 106496
    v_add_u32 v55, s5, v53
    s_lshl_b32 s5, s38, 10
    v_add_u32 v54, s5, v55
    ds_write_b128 v54, v[72:75]
    s_cmp_lg_u32 s38, 0
    s_cbranch_scc1 Lnozl
    v_add_f32 v24, v24, v28
    v_add_f32 v32, v32, v36
    v_add_f32 v24, v24, v32
    v_add_f32 v25, v25, v29
    v_add_f32 v33, v33, v37
    v_add_f32 v25, v25, v33
    v_add_f32 v26, v26, v30
    v_add_f32 v34, v34, v38
    v_add_f32 v26, v26, v34
    v_add_f32 v27, v27, v31
    v_add_f32 v35, v35, v39
    v_add_f32 v27, v27, v35
    v_mov_b32 v45, v24
    v_mov_b32 v46, v24
    s_nop 1
    v_permlane32_swap_b32 v45, v46
    s_nop 1
    v_add_f32 v24, v45, v46
    v_mov_b32 v45, v24
    v_mov_b32 v46, v24
    s_nop 1
    v_permlane16_swap_b32 v45, v46
    s_nop 1
    v_add_f32 v24, v45, v46
    v_mov_b32 v45, v25
    v_mov_b32 v46, v25
    s_nop 1
    v_permlane32_swap_b32 v45, v46
    s_nop 1
    v_add_f32 v25, v45, v46
    v_mov_b32 v45, v25
    v_mov_b32 v46, v25
    s_nop 1
    v_permlane16_swap_b32 v45, v46
    s_nop 1
    v_add_f32 v25, v45, v46
    v_mov_b32 v45, v26
    v_mov_b32 v46, v26
    s_nop 1
    v_permlane32_swap_b32 v45, v46
    s_nop 1
    v_add_f32 v26, v45, v46
    v_mov_b32 v45, v26
    v_mov_b32 v46, v26
    s_nop 1
    v_permlane16_swap_b32 v45, v46
    s_nop 1
    v_add_f32 v26, v45, v46
    v_mov_b32 v45, v27
    v_mov_b32 v46, v27
    s_nop 1
    v_permlane32_swap_b32 v45, v46
    s_nop 1
    v_add_f32 v27, v45, v46
    v_mov_b32 v45, v27
    v_mov_b32 v46, v27
    s_nop 1
    v_permlane16_swap_b32 v45, v46
    s_nop 1
    v_add_f32 v27, v45, v46
    v_cvt_pk_bf16_f32 v40, v24, v25
    v_cvt_pk_bf16_f32 v41, v26, v27
    v_and_b32 v42, 15, v0
    v_lshlrev_b32 v42, 3, v42
    s_and_b32 s5, s3, 1
    s_mul_i32 s5, s5, 4352
    s_add_u32 s5, s5, 110592
    v_add_u32 v42, s5, v42
    ds_write_b64 v42, v[40:41]
Lnozl:
    s_waitcnt vmcnt(0) lgkmcnt(0)
    s_barrier
    s_cmp_lg_u32 s3, 4
    s_cbranch_scc1 Lnsa
    s_and_b32 s41, s2, 3
    s_lshl_b32 s5, s41, 8
    s_add_u32 s5, s5, 12288
    v_mov_b32 v54, s5
    v_mov_b32 v44, 1
    s_mov_b64 exec, 1
    buffer_atomic_add v44, v54, s[8:11], 0 offen sc1
    s_mov_b64 exec, -1
Lnsa:
    s_and_b32 s5, s3, 1
    s_mul_i32 s5, s5, 4352
    s_add_u32 s5, s5, 110592
    v_lshlrev_b32 v42, 3, v51
    v_add_u32 v42, s5, v42
    ds_read_b128 v[64:67], v55 offset:0
    ds_read_b64 v[80:81], v42 offset:0
    ds_read_b64 v[82:83], v42 offset:16
    ds_read_b128 v[68:71], v55 offset:1024
    ds_read_b64 v[84:85], v42 offset:32
    ds_read_b64 v[86:87], v42 offset:48
    ds_read_b128 v[72:75], v55 offset:2048
    ds_read_b64 v[88:89], v42 offset:64
    ds_read_b64 v[90:91], v42 offset:80
    ds_read_b128 v[76:79], v55 offset:3072
    ds_read_b64 v[92:93], v42 offset:96
    ds_read_b64 v[94:95], v42 offset:112
    s_add_u32 s12, s34, 12582912
    s_addc_u32 s13, s35, 0
    s_mov_b32 s14, 4194304
    s_mov_b32 s15, 0x00020000
    s_bfe_u32 s5, s3, 0x10001
    s_lshl_b32 s5, s5, 17
    s_add_u32 s5, s5, s36
    s_lshr_b32 s41, s3, 2
    s_lshl_b32 s41, s41, 16
    s_add_u32 s5, s5, s41
    s_lshl_b32 s41, s39, 6
    s_add_u32 s5, s5, s41
    v_and_b32 v52, 31, v0
    v_lshlrev_b32 v52, 11, v52
    v_lshl_add_u32 v52, v51, 4, v52
    v_add_u32 v52, s5, v52
    s_mov_b32 s41, 0x358637bd
    s_waitcnt lgkmcnt(0)
    v_mfma_f32_32x32x16_bf16 v[96:111], v[64:67], v[224:227], 0
    v_mfma_f32_32x32x16_bf16 v[96:111], v[68:71], v[228:231], v[96:111]
    v_mfma_f32_32x32x16_bf16 v[96:111], v[72:75], v[232:235], v[96:111]
    v_mfma_f32_32x32x16_bf16 v[96:111], v[76:79], v[236:239], v[96:111]
    v_mfma_f32_32x32x16_bf16 v[112:127], v[80:83], v[224:227], 0
    v_mfma_f32_32x32x16_bf16 v[112:127], v[84:87], v[228:231], v[112:127]
    v_mfma_f32_32x32x16_bf16 v[112:127], v[88:91], v[232:235], v[112:127]
    v_mfma_f32_32x32x16_bf16 v[112:127], v[92:95], v[236:239], v[112:127]
    s_nop 7
    s_nop 4
    v_mov_b32 v41, s41
    v_cvt_pk_bf16_f32 v40, v112, v41
    v_lshlrev_b32 v112, 16, v40
    v_and_b32 v41, 0xffff0000, v40
    v_add_f32 v112, v112, v41
    v_cvt_pk_bf16_f32 v40, v112, v41
    v_lshlrev_b32 v112, 16, v40
    v_and_b32 v41, 0xffff0000, v40
    v_rcp_f32 v112, v112
    v_cvt_pk_bf16_f32 v40, v96, v97
    v_lshlrev_b32 v96, 16, v40
    v_and_b32 v97, 0xffff0000, v40
    v_cvt_pk_bf16_f32 v40, v98, v99
    v_lshlrev_b32 v98, 16, v40
    v_and_b32 v99, 0xffff0000, v40
    v_cvt_pk_bf16_f32 v40, v100, v101
    v_lshlrev_b32 v100, 16, v40
    v_and_b32 v101, 0xffff0000, v40
    v_cvt_pk_bf16_f32 v40, v102, v103
    v_lshlrev_b32 v102, 16, v40
    v_and_b32 v103, 0xffff0000, v40
    v_cvt_pk_bf16_f32 v40, v104, v105
    v_lshlrev_b32 v104, 16, v40
    v_and_b32 v105, 0xffff0000, v40
    v_cvt_pk_bf16_f32 v40, v106, v107
    v_lshlrev_b32 v106, 16, v40
    v_and_b32 v107, 0xffff0000, v40
    v_cvt_pk_bf16_f32 v40, v108, v109
    v_lshlrev_b32 v108, 16, v40
    v_and_b32 v109, 0xffff0000, v40
    v_cvt_pk_bf16_f32 v40, v110, v111
    v_lshlrev_b32 v110, 16, v40
    v_and_b32 v111, 0xffff0000, v40
    v_mul_f32 v96, v96, v112
    v_mul_f32 v97, v97, v112
    v_mul_f32 v98, v98, v112
    v_mul_f32 v99, v99, v112
    v_mul_f32 v100, v100, v112
    v_mul_f32 v101, v101, v112
    v_mul_f32 v102, v102, v112
    v_mul_f32 v103, v103, v112
    v_mul_f32 v104, v104, v112
    v_mul_f32 v105, v105, v112
    v_mul_f32 v106, v106, v112
    v_mul_f32 v107, v107, v112
    v_mul_f32 v108, v108, v112
    v_mul_f32 v109, v109, v112
    v_mul_f32 v110, v110, v112
    v_mul_f32 v111, v111, v112
    v_cvt_pk_bf16_f32 v128, v96, v97
    v_cvt_pk_bf16_f32 v129, v98, v99
    v_cvt_pk_bf16_f32 v130, v100, v101
    v_cvt_pk_bf16_f32 v131, v102, v103
    v_cvt_pk_bf16_f32 v132, v104, v105
    v_cvt_pk_bf16_f32 v133, v106, v107
    v_cvt_pk_bf16_f32 v134, v108, v109
    v_cvt_pk_bf16_f32 v135, v110, v111
    s_nop 1
    v_permlane32_swap_b32 v128, v130
    v_permlane32_swap_b32 v129, v131
    v_permlane32_swap_b32 v132, v134
    v_permlane32_swap_b32 v133, v135
    buffer_store_dwordx4 v[128:131], v52, s[12:15], 0 offen offset:0 sc1
    buffer_store_dwordx4 v[132:135], v52, s[12:15], 0 offen offset:32 sc1
    s_cmp_lg_u32 s3, 5
    s_cbranch_scc1 Lnpa
    s_lshr_b32 s41, s2, 6
    s_lshl_b32 s5, s41, 8
    s_add_u32 s5, s5, 12288
    v_mov_b32 v54, s5
    s_mov_b32 s99, 0
    Lpoll_a:
    buffer_load_dword v55, v54, s[8:11], 0 offen sc1
    s_waitcnt vmcnt(0)
    v_readfirstlane_b32 s5, v55
    s_nop 3
    s_cmp_ge_u32 s5, 64
    s_cbranch_scc1 Lpoll_a_done
    s_sleep 2
    s_add_u32 s99, s99, 1
    s_cmp_lt_u32 s99, 0x40000
    s_cbranch_scc1 Lpoll_a
    Lpoll_a_done:
Lnpa:
    s_waitcnt vmcnt(0)
    s_barrier
    s_cmp_ge_u32 s3, 4
    s_cbranch_scc1 Lp3_loader
    s_add_u32 m0, s58, 16640
    s_add_u32 s77, s76, 0
    buffer_load_dwordx4 v2, s[64:67], s77 offen sc1 lds
    s_add_u32 m0, s58, 17664
    s_add_u32 s77, s76, 1024
    buffer_load_dwordx4 v2, s[64:67], s77 offen sc1 lds
    s_add_u32 m0, s58, 18688
    s_add_u32 s77, s76, 2048
    buffer_load_dwordx4 v2, s[64:67], s77 offen sc1 lds
    s_add_u32 m0, s58, 19712
    s_add_u32 s77, s76, 3072
    buffer_load_dwordx4 v2, s[64:67], s77 offen sc1 lds
    v_mov_b32 v7, s57
    v_lshlrev_b32 v7, 1, v7
    buffer_load_ushort v7, v7, s[68:71], 0 offen
    v_and_b32 v2, 15, v0
    v_lshrrev_b32 v3, 4, v0
    v_add_u32 v8, 1, v2
    v_and_b32 v4, 3, v8
    v_mul_u32_u24 v4, 4160, v4
    v_lshrrev_b32 v8, 2, v8
    v_lshl_add_u32 v4, v8, 3, v4
    v_lshl_add_u32 v4, v3, 4, v4
    v_add_u32 v4, s58, v4
    v_lshlrev_b32 v5, 5, v2
    v_lshlrev_b32 v8, 4, v3
    v_sub_u32 v5, v8, v5
    v_add_u32 v5, s58, v5
    v_add_u32 v5, 17120, v5
    v_mov_b32 v14, 0
    v_mov_b32 v15, 0
    v_mov_b32 v16, 0
    v_mov_b32 v17, 0
    v_mov_b32 v18, 0
    v_mov_b32 v19, 0
    v_mov_b32 v20, 0
    v_mov_b32 v21, 0
    v_mov_b32 v22, 0
    v_mov_b32 v23, 0
    v_mov_b32 v24, 0
    v_mov_b32 v25, 0
    v_mov_b32 v26, 0
    v_mov_b32 v27, 0
    v_mov_b32 v28, 0
    v_mov_b32 v29, 0
    v_mov_b32 v30, 0
    v_mov_b32 v31, 0
    v_mov_b32 v32, 0
    v_mov_b32 v33, 0
    v_mov_b32 v34, 0
    v_mov_b32 v35, 0
    v_mov_b32 v36, 0
    v_mov_b32 v37, 0
    v_mov_b32 v38, 0
    v_mov_b32 v39, 0
    v_mov_b32 v40, 0
    v_mov_b32 v41, 0
    v_mov_b32 v42, 0
    v_mov_b32 v43, 0
    v_mov_b32 v44, 0
    v_mov_b32 v45, 0
    s_waitcnt vmcnt(1) lgkmcnt(0)
    ds_read_b64 v[46:47], v4 offset:0
    ds_read_b64 v[48:49], v4 offset:8
    ds_read_b128 v[78:81], v5 offset:3584
    ds_read_b64 v[50:51], v4 offset:512
    ds_read_b64 v[52:53], v4 offset:520
    ds_read_b128 v[82:85], v5 offset:3072
    ds_read_b64 v[54:55], v4 offset:1024
    ds_read_b64 v[56:57], v4 offset:1032
    ds_read_b128 v[86:89], v5 offset:2560
    ds_read_b64 v[58:59], v4 offset:1536
    ds_read_b64 v[60:61], v4 offset:1544
    ds_read_b128 v[90:93], v5 offset:2048
    ds_read_b64 v[62:63], v4 offset:2048
    ds_read_b64 v[64:65], v4 offset:2056
    ds_read_b128 v[94:97], v5 offset:1536
    ds_read_b64 v[66:67], v4 offset:2560
    ds_read_b64 v[68:69], v4 offset:2568
    ds_read_b128 v[98:101], v5 offset:1024
    ds_read_b64 v[70:71], v4 offset:3072
    ds_read_b64 v[72:73], v4 offset:3080
    ds_read_b128 v[102:105], v5 offset:512
    ds_read_b64 v[74:75], v4 offset:3584
    ds_read_b64 v[76:77], v4 offset:3592
    ds_read_b128 v[106:109], v5 offset:0
    s_waitcnt lgkmcnt(0)
    v_mfma_f32_16x16x32_bf16 v[14:17], v[46:49], v[78:81], v[14:17]
    v_mfma_f32_16x16x32_bf16 v[18:21], v[46:49], v[82:85], v[18:21]
    v_mfma_f32_16x16x32_bf16 v[18:21], v[50:53], v[78:81], v[18:21]
    ds_read_b64 v[110:111], v4 offset:64
    ds_read_b64 v[112:113], v4 offset:72
    ds_read_b128 v[142:145], v5 offset:3648
    v_mfma_f32_16x16x32_bf16 v[22:25], v[46:49], v[86:89], v[22:25]
    v_mfma_f32_16x16x32_bf16 v[22:25], v[50:53], v[82:85], v[22:25]
    v_mfma_f32_16x16x32_bf16 v[22:25], v[54:57], v[78:81], v[22:25]
    ds_read_b64 v[114:115], v4 offset:576
    ds_read_b64 v[116:117], v4 offset:584
    ds_read_b128 v[146:149], v5 offset:3136
    v_mfma_f32_16x16x32_bf16 v[26:29], v[46:49], v[90:93], v[26:29]
    v_mfma_f32_16x16x32_bf16 v[26:29], v[50:53], v[86:89], v[26:29]
    v_mfma_f32_16x16x32_bf16 v[26:29], v[54:57], v[82:85], v[26:29]
    ds_read_b64 v[118:119], v4 offset:1088
    ds_read_b64 v[120:121], v4 offset:1096
    ds_read_b128 v[150:153], v5 offset:2624
    v_mfma_f32_16x16x32_bf16 v[26:29], v[58:61], v[78:81], v[26:29]
    v_mfma_f32_16x16x32_bf16 v[30:33], v[46:49], v[94:97], v[30:33]
    v_mfma_f32_16x16x32_bf16 v[30:33], v[50:53], v[90:93], v[30:33]
    ds_read_b64 v[122:123], v4 offset:1600
    ds_read_b64 v[124:125], v4 offset:1608
    ds_read_b128 v[154:157], v5 offset:2112
    v_mfma_f32_16x16x32_bf16 v[30:33], v[54:57], v[86:89], v[30:33]
    v_mfma_f32_16x16x32_bf16 v[30:33], v[58:61], v[82:85], v[30:33]
    v_mfma_f32_16x16x32_bf16 v[30:33], v[62:65], v[78:81], v[30:33]
    ds_read_b64 v[126:127], v4 offset:2112
    ds_read_b64 v[128:129], v4 offset:2120
    ds_read_b128 v[158:161], v5 offset:1600
    v_mfma_f32_16x16x32_bf16 v[34:37], v[46:49], v[98:101], v[34:37]
    v_mfma_f32_16x16x32_bf16 v[34:37], v[50:53], v[94:97], v[34:37]
    v_mfma_f32_16x16x32_bf16 v[34:37], v[54:57], v[90:93], v[34:37]
    ds_read_b64 v[130:131], v4 offset:2624
    ds_read_b64 v[132:133], v4 offset:2632
    ds_read_b128 v[162:165], v5 offset:1088
    v_mfma_f32_16x16x32_bf16 v[34:37], v[58:61], v[86:89], v[34:37]
    v_mfma_f32_16x16x32_bf16 v[34:37], v[62:65], v[82:85], v[34:37]
    v_mfma_f32_16x16x32_bf16 v[34:37], v[66:69], v[78:81], v[34:37]
    ds_read_b64 v[134:135], v4 offset:3136
    ds_read_b64 v[136:137], v4 offset:3144
    ds_read_b128 v[166:169], v5 offset:576
    v_mfma_f32_16x16x32_bf16 v[38:41], v[46:49], v[102:105], v[38:41]
    v_mfma_f32_16x16x32_bf16 v[38:41], v[50:53], v[98:101], v[38:41]
    v_mfma_f32_16x16x32_bf16 v[38:41], v[54:57], v[94:97], v[38:41]
    ds_read_b64 v[138:139], v4 offset:3648
    ds_read_b64 v[140:141], v4 offset:3656
    ds_read_b128 v[170:173], v5 offset:64
    v_mfma_f32_16x16x32_bf16 v[38:41], v[58:61], v[90:93], v[38:41]
    v_mfma_f32_16x16x32_bf16 v[38:41], v[62:65], v[86:89], v[38:41]
    v_mfma_f32_16x16x32_bf16 v[38:41], v[66:69], v[82:85], v[38:41]
    v_mfma_f32_16x16x32_bf16 v[38:41], v[70:73], v[78:81], v[38:41]
    v_mfma_f32_16x16x32_bf16 v[42:45], v[46:49], v[106:109], v[42:45]
    v_mfma_f32_16x16x32_bf16 v[42:45], v[50:53], v[102:105], v[42:45]
    v_mfma_f32_16x16x32_bf16 v[42:45], v[54:57], v[98:101], v[42:45]
    v_mfma_f32_16x16x32_bf16 v[42:45], v[58:61], v[94:97], v[42:45]
    v_mfma_f32_16x16x32_bf16 v[42:45], v[62:65], v[90:93], v[42:45]
    v_mfma_f32_16x16x32_bf16 v[42:45], v[66:69], v[86:89], v[42:45]
    v_mfma_f32_16x16x32_bf16 v[42:45], v[70:73], v[82:85], v[42:45]
    v_mfma_f32_16x16x32_bf16 v[42:45], v[74:77], v[78:81], v[42:45]
    s_waitcnt lgkmcnt(0)
    v_mfma_f32_16x16x32_bf16 v[14:17], v[110:113], v[142:145], v[14:17]
    v_mfma_f32_16x16x32_bf16 v[18:21], v[110:113], v[146:149], v[18:21]
    v_mfma_f32_16x16x32_bf16 v[18:21], v[114:117], v[142:145], v[18:21]
    ds_read_b64 v[46:47], v4 offset:128
    ds_read_b64 v[48:49], v4 offset:136
    ds_read_b128 v[78:81], v5 offset:3712
    v_mfma_f32_16x16x32_bf16 v[22:25], v[110:113], v[150:153], v[22:25]
    v_mfma_f32_16x16x32_bf16 v[22:25], v[114:117], v[146:149], v[22:25]
    v_mfma_f32_16x16x32_bf16 v[22:25], v[118:121], v[142:145], v[22:25]
    ds_read_b64 v[50:51], v4 offset:640
    ds_read_b64 v[52:53], v4 offset:648
    ds_read_b128 v[82:85], v5 offset:3200
    v_mfma_f32_16x16x32_bf16 v[26:29], v[110:113], v[154:157], v[26:29]
    v_mfma_f32_16x16x32_bf16 v[26:29], v[114:117], v[150:153], v[26:29]
    v_mfma_f32_16x16x32_bf16 v[26:29], v[118:121], v[146:149], v[26:29]
    ds_read_b64 v[54:55], v4 offset:1152
    ds_read_b64 v[56:57], v4 offset:1160
    ds_read_b128 v[86:89], v5 offset:2688
    v_mfma_f32_16x16x32_bf16 v[26:29], v[122:125], v[142:145], v[26:29]
    v_mfma_f32_16x16x32_bf16 v[30:33], v[110:113], v[158:161], v[30:33]
    v_mfma_f32_16x16x32_bf16 v[30:33], v[114:117], v[154:157], v[30:33]
    ds_read_b64 v[58:59], v4 offset:1664
    ds_read_b64 v[60:61], v4 offset:1672
    ds_read_b128 v[90:93], v5 offset:2176
    v_mfma_f32_16x16x32_bf16 v[30:33], v[118:121], v[150:153], v[30:33]
    v_mfma_f32_16x16x32_bf16 v[30:33], v[122:125], v[146:149], v[30:33]
    v_mfma_f32_16x16x32_bf16 v[30:33], v[126:129], v[142:145], v[30:33]
    ds_read_b64 v[62:63], v4 offset:2176
    ds_read_b64 v[64:65], v4 offset:2184
    ds_read_b128 v[94:97], v5 offset:1664
    v_mfma_f32_16x16x32_bf16 v[34:37], v[110:113], v[162:165], v[34:37]
    v_mfma_f32_16x16x32_bf16 v[34:37], v[114:117], v[158:161], v[34:37]
    v_mfma_f32_16x16x32_bf16 v[34:37], v[118:121], v[154:157], v[34:37]
    ds_read_b64 v[66:67], v4 offset:2688
    ds_read_b64 v[68:69], v4 offset:2696
    ds_read_b128 v[98:101], v5 offset:1152
    v_mfma_f32_16x16x32_bf16 v[34:37], v[122:125], v[150:153], v[34:37]
    v_mfma_f32_16x16x32_bf16 v[34:37], v[126:129], v[146:149], v[34:37]
    v_mfma_f32_16x16x32_bf16 v[34:37], v[130:133], v[142:145], v[34:37]
    ds_read_b64 v[70:71], v4 offset:3200
    ds_read_b64 v[72:73], v4 offset:3208
    ds_read_b128 v[102:105], v5 offset:640
    v_mfma_f32_16x16x32_bf16 v[38:41], v[110:113], v[166:169], v[38:41]
    v_mfma_f32_16x16x32_bf16 v[38:41], v[114:117], v[162:165], v[38:41]
    v_mfma_f32_16x16x32_bf16 v[38:41], v[118:121], v[158:161], v[38:41]
    ds_read_b64 v[74:75], v4 offset:3712
    ds_read_b64 v[76:77], v4 offset:3720
    ds_read_b128 v[106:109], v5 offset:128
    v_mfma_f32_16x16x32_bf16 v[38:41], v[122:125], v[154:157], v[38:41]
    v_mfma_f32_16x16x32_bf16 v[38:41], v[126:129], v[150:153], v[38:41]
    v_mfma_f32_16x16x32_bf16 v[38:41], v[130:133], v[146:149], v[38:41]
    v_mfma_f32_16x16x32_bf16 v[38:41], v[134:137], v[142:145], v[38:41]
    v_mfma_f32_16x16x32_bf16 v[42:45], v[110:113], v[170:173], v[42:45]
    v_mfma_f32_16x16x32_bf16 v[42:45], v[114:117], v[166:169], v[42:45]
    v_mfma_f32_16x16x32_bf16 v[42:45], v[118:121], v[162:165], v[42:45]
    v_mfma_f32_16x16x32_bf16 v[42:45], v[122:125], v[158:161], v[42:45]
    v_mfma_f32_16x16x32_bf16 v[42:45], v[126:129], v[154:157], v[42:45]
    v_mfma_f32_16x16x32_bf16 v[42:45], v[130:133], v[150:153], v[42:45]
    v_mfma_f32_16x16x32_bf16 v[42:45], v[134:137], v[146:149], v[42:45]
    v_mfma_f32_16x16x32_bf16 v[42:45], v[138:141], v[142:145], v[42:45]
    s_waitcnt lgkmcnt(0)
    v_mfma_f32_16x16x32_bf16 v[14:17], v[46:49], v[78:81], v[14:17]
    v_mfma_f32_16x16x32_bf16 v[18:21], v[46:49], v[82:85], v[18:21]
    v_mfma_f32_16x16x32_bf16 v[18:21], v[50:53], v[78:81], v[18:21]
    ds_read_b64 v[110:111], v4 offset:192
    ds_read_b64 v[112:113], v4 offset:200
    ds_read_b128 v[142:145], v5 offset:3776
    v_mfma_f32_16x16x32_bf16 v[22:25], v[46:49], v[86:89], v[22:25]
    v_mfma_f32_16x16x32_bf16 v[22:25], v[50:53], v[82:85], v[22:25]
    v_mfma_f32_16x16x32_bf16 v[22:25], v[54:57], v[78:81], v[22:25]
    ds_read_b64 v[114:115], v4 offset:704
    ds_read_b64 v[116:117], v4 offset:712
    ds_read_b128 v[146:149], v5 offset:3264
    v_mfma_f32_16x16x32_bf16 v[26:29], v[46:49], v[90:93], v[26:29]
    v_mfma_f32_16x16x32_bf16 v[26:29], v[50:53], v[86:89], v[26:29]
    v_mfma_f32_16x16x32_bf16 v[26:29], v[54:57], v[82:85], v[26:29]
    ds_read_b64 v[118:119], v4 offset:1216
    ds_read_b64 v[120:121], v4 offset:1224
    ds_read_b128 v[150:153], v5 offset:2752
    v_mfma_f32_16x16x32_bf16 v[26:29], v[58:61], v[78:81], v[26:29]
    v_mfma_f32_16x16x32_bf16 v[30:33], v[46:49], v[94:97], v[30:33]
    v_mfma_f32_16x16x32_bf16 v[30:33], v[50:53], v[90:93], v[30:33]
    ds_read_b64 v[122:123], v4 offset:1728
    ds_read_b64 v[124:125], v4 offset:1736
    ds_read_b128 v[154:157], v5 offset:2240
    v_mfma_f32_16x16x32_bf16 v[30:33], v[54:57], v[86:89], v[30:33]
    v_mfma_f32_16x16x32_bf16 v[30:33], v[58:61], v[82:85], v[30:33]
    v_mfma_f32_16x16x32_bf16 v[30:33], v[62:65], v[78:81], v[30:33]
    ds_read_b64 v[126:127], v4 offset:2240
    ds_read_b64 v[128:129], v4 offset:2248
    ds_read_b128 v[158:161], v5 offset:1728
    v_mfma_f32_16x16x32_bf16 v[34:37], v[46:49], v[98:101], v[34:37]
    v_mfma_f32_16x16x32_bf16 v[34:37], v[50:53], v[94:97], v[34:37]
    v_mfma_f32_16x16x32_bf16 v[34:37], v[54:57], v[90:93], v[34:37]
    ds_read_b64 v[130:131], v4 offset:2752
    ds_read_b64 v[132:133], v4 offset:2760
    ds_read_b128 v[162:165], v5 offset:1216
    v_mfma_f32_16x16x32_bf16 v[34:37], v[58:61], v[86:89], v[34:37]
    v_mfma_f32_16x16x32_bf16 v[34:37], v[62:65], v[82:85], v[34:37]
    v_mfma_f32_16x16x32_bf16 v[34:37], v[66:69], v[78:81], v[34:37]
    ds_read_b64 v[134:135], v4 offset:3264
    ds_read_b64 v[136:137], v4 offset:3272
    ds_read_b128 v[166:169], v5 offset:704
    v_mfma_f32_16x16x32_bf16 v[38:41], v[46:49], v[102:105], v[38:41]
    v_mfma_f32_16x16x32_bf16 v[38:41], v[50:53], v[98:101], v[38:41]
    v_mfma_f32_16x16x32_bf16 v[38:41], v[54:57], v[94:97], v[38:41]
    ds_read_b64 v[138:139], v4 offset:3776
    ds_read_b64 v[140:141], v4 offset:3784
    ds_read_b128 v[170:173], v5 offset:192
    v_mfma_f32_16x16x32_bf16 v[38:41], v[58:61], v[90:93], v[38:41]
    v_mfma_f32_16x16x32_bf16 v[38:41], v[62:65], v[86:89], v[38:41]
    v_mfma_f32_16x16x32_bf16 v[38:41], v[66:69], v[82:85], v[38:41]
    v_mfma_f32_16x16x32_bf16 v[38:41], v[70:73], v[78:81], v[38:41]
    v_mfma_f32_16x16x32_bf16 v[42:45], v[46:49], v[106:109], v[42:45]
    v_mfma_f32_16x16x32_bf16 v[42:45], v[50:53], v[102:105], v[42:45]
    v_mfma_f32_16x16x32_bf16 v[42:45], v[54:57], v[98:101], v[42:45]
    v_mfma_f32_16x16x32_bf16 v[42:45], v[58:61], v[94:97], v[42:45]
    v_mfma_f32_16x16x32_bf16 v[42:45], v[62:65], v[90:93], v[42:45]
    v_mfma_f32_16x16x32_bf16 v[42:45], v[66:69], v[86:89], v[42:45]
    v_mfma_f32_16x16x32_bf16 v[42:45], v[70:73], v[82:85], v[42:45]
    v_mfma_f32_16x16x32_bf16 v[42:45], v[74:77], v[78:81], v[42:45]
    s_waitcnt lgkmcnt(0)
    v_mfma_f32_16x16x32_bf16 v[14:17], v[110:113], v[142:145], v[14:17]
    v_mfma_f32_16x16x32_bf16 v[18:21], v[110:113], v[146:149], v[18:21]
    v_mfma_f32_16x16x32_bf16 v[18:21], v[114:117], v[142:145], v[18:21]
    ds_read_b64 v[46:47], v4 offset:256
    ds_read_b64 v[48:49], v4 offset:264
    ds_read_b128 v[78:81], v5 offset:3840
    v_mfma_f32_16x16x32_bf16 v[22:25], v[110:113], v[150:153], v[22:25]
    v_mfma_f32_16x16x32_bf16 v[22:25], v[114:117], v[146:149], v[22:25]
    v_mfma_f32_16x16x32_bf16 v[22:25], v[118:121], v[142:145], v[22:25]
    ds_read_b64 v[50:51], v4 offset:768
    ds_read_b64 v[52:53], v4 offset:776
    ds_read_b128 v[82:85], v5 offset:3328
    v_mfma_f32_16x16x32_bf16 v[26:29], v[110:113], v[154:157], v[26:29]
    v_mfma_f32_16x16x32_bf16 v[26:29], v[114:117], v[150:153], v[26:29]
    v_mfma_f32_16x16x32_bf16 v[26:29], v[118:121], v[146:149], v[26:29]
    ds_read_b64 v[54:55], v4 offset:1280
    ds_read_b64 v[56:57], v4 offset:1288
    ds_read_b128 v[86:89], v5 offset:2816
    v_mfma_f32_16x16x32_bf16 v[26:29], v[122:125], v[142:145], v[26:29]
    v_mfma_f32_16x16x32_bf16 v[30:33], v[110:113], v[158:161], v[30:33]
    v_mfma_f32_16x16x32_bf16 v[30:33], v[114:117], v[154:157], v[30:33]
    ds_read_b64 v[58:59], v4 offset:1792
    ds_read_b64 v[60:61], v4 offset:1800
    ds_read_b128 v[90:93], v5 offset:2304
    v_mfma_f32_16x16x32_bf16 v[30:33], v[118:121], v[150:153], v[30:33]
    v_mfma_f32_16x16x32_bf16 v[30:33], v[122:125], v[146:149], v[30:33]
    v_mfma_f32_16x16x32_bf16 v[30:33], v[126:129], v[142:145], v[30:33]
    ds_read_b64 v[62:63], v4 offset:2304
    ds_read_b64 v[64:65], v4 offset:2312
    ds_read_b128 v[94:97], v5 offset:1792
    v_mfma_f32_16x16x32_bf16 v[34:37], v[110:113], v[162:165], v[34:37]
    v_mfma_f32_16x16x32_bf16 v[34:37], v[114:117], v[158:161], v[34:37]
    v_mfma_f32_16x16x32_bf16 v[34:37], v[118:121], v[154:157], v[34:37]
    ds_read_b64 v[66:67], v4 offset:2816
    ds_read_b64 v[68:69], v4 offset:2824
    ds_read_b128 v[98:101], v5 offset:1280
    v_mfma_f32_16x16x32_bf16 v[34:37], v[122:125], v[150:153], v[34:37]
    v_mfma_f32_16x16x32_bf16 v[34:37], v[126:129], v[146:149], v[34:37]
    v_mfma_f32_16x16x32_bf16 v[34:37], v[130:133], v[142:145], v[34:37]
    ds_read_b64 v[70:71], v4 offset:3328
    ds_read_b64 v[72:73], v4 offset:3336
    ds_read_b128 v[102:105], v5 offset:768
    v_mfma_f32_16x16x32_bf16 v[38:41], v[110:113], v[166:169], v[38:41]
    v_mfma_f32_16x16x32_bf16 v[38:41], v[114:117], v[162:165], v[38:41]
    v_mfma_f32_16x16x32_bf16 v[38:41], v[118:121], v[158:161], v[38:41]
    ds_read_b64 v[74:75], v4 offset:3840
    ds_read_b64 v[76:77], v4 offset:3848
    ds_read_b128 v[106:109], v5 offset:256
    v_mfma_f32_16x16x32_bf16 v[38:41], v[122:125], v[154:157], v[38:41]
    v_mfma_f32_16x16x32_bf16 v[38:41], v[126:129], v[150:153], v[38:41]
    v_mfma_f32_16x16x32_bf16 v[38:41], v[130:133], v[146:149], v[38:41]
    v_mfma_f32_16x16x32_bf16 v[38:41], v[134:137], v[142:145], v[38:41]
    v_mfma_f32_16x16x32_bf16 v[42:45], v[110:113], v[170:173], v[42:45]
    v_mfma_f32_16x16x32_bf16 v[42:45], v[114:117], v[166:169], v[42:45]
    v_mfma_f32_16x16x32_bf16 v[42:45], v[118:121], v[162:165], v[42:45]
    v_mfma_f32_16x16x32_bf16 v[42:45], v[122:125], v[158:161], v[42:45]
    v_mfma_f32_16x16x32_bf16 v[42:45], v[126:129], v[154:157], v[42:45]
    v_mfma_f32_16x16x32_bf16 v[42:45], v[130:133], v[150:153], v[42:45]
    v_mfma_f32_16x16x32_bf16 v[42:45], v[134:137], v[146:149], v[42:45]
    v_mfma_f32_16x16x32_bf16 v[42:45], v[138:141], v[142:145], v[42:45]
    s_waitcnt lgkmcnt(0)
    v_mfma_f32_16x16x32_bf16 v[14:17], v[46:49], v[78:81], v[14:17]
    v_mfma_f32_16x16x32_bf16 v[18:21], v[46:49], v[82:85], v[18:21]
    v_mfma_f32_16x16x32_bf16 v[18:21], v[50:53], v[78:81], v[18:21]
    ds_read_b64 v[110:111], v4 offset:320
    ds_read_b64 v[112:113], v4 offset:328
    ds_read_b128 v[142:145], v5 offset:3904
    v_mfma_f32_16x16x32_bf16 v[22:25], v[46:49], v[86:89], v[22:25]
    v_mfma_f32_16x16x32_bf16 v[22:25], v[50:53], v[82:85], v[22:25]
    v_mfma_f32_16x16x32_bf16 v[22:25], v[54:57], v[78:81], v[22:25]
    ds_read_b64 v[114:115], v4 offset:832
    ds_read_b64 v[116:117], v4 offset:840
    ds_read_b128 v[146:149], v5 offset:3392
    v_mfma_f32_16x16x32_bf16 v[26:29], v[46:49], v[90:93], v[26:29]
    v_mfma_f32_16x16x32_bf16 v[26:29], v[50:53], v[86:89], v[26:29]
    v_mfma_f32_16x16x32_bf16 v[26:29], v[54:57], v[82:85], v[26:29]
    ds_read_b64 v[118:119], v4 offset:1344
    ds_read_b64 v[120:121], v4 offset:1352
    ds_read_b128 v[150:153], v5 offset:2880
    v_mfma_f32_16x16x32_bf16 v[26:29], v[58:61], v[78:81], v[26:29]
    v_mfma_f32_16x16x32_bf16 v[30:33], v[46:49], v[94:97], v[30:33]
    v_mfma_f32_16x16x32_bf16 v[30:33], v[50:53], v[90:93], v[30:33]
    ds_read_b64 v[122:123], v4 offset:1856
    ds_read_b64 v[124:125], v4 offset:1864
    ds_read_b128 v[154:157], v5 offset:2368
    v_mfma_f32_16x16x32_bf16 v[30:33], v[54:57], v[86:89], v[30:33]
    v_mfma_f32_16x16x32_bf16 v[30:33], v[58:61], v[82:85], v[30:33]
    v_mfma_f32_16x16x32_bf16 v[30:33], v[62:65], v[78:81], v[30:33]
    ds_read_b64 v[126:127], v4 offset:2368
    ds_read_b64 v[128:129], v4 offset:2376
    ds_read_b128 v[158:161], v5 offset:1856
    v_mfma_f32_16x16x32_bf16 v[34:37], v[46:49], v[98:101], v[34:37]
    v_mfma_f32_16x16x32_bf16 v[34:37], v[50:53], v[94:97], v[34:37]
    v_mfma_f32_16x16x32_bf16 v[34:37], v[54:57], v[90:93], v[34:37]
    ds_read_b64 v[130:131], v4 offset:2880
    ds_read_b64 v[132:133], v4 offset:2888
    ds_read_b128 v[162:165], v5 offset:1344
    v_mfma_f32_16x16x32_bf16 v[34:37], v[58:61], v[86:89], v[34:37]
    v_mfma_f32_16x16x32_bf16 v[34:37], v[62:65], v[82:85], v[34:37]
    v_mfma_f32_16x16x32_bf16 v[34:37], v[66:69], v[78:81], v[34:37]
    ds_read_b64 v[134:135], v4 offset:3392
    ds_read_b64 v[136:137], v4 offset:3400
    ds_read_b128 v[166:169], v5 offset:832
    v_mfma_f32_16x16x32_bf16 v[38:41], v[46:49], v[102:105], v[38:41]
    v_mfma_f32_16x16x32_bf16 v[38:41], v[50:53], v[98:101], v[38:41]
    v_mfma_f32_16x16x32_bf16 v[38:41], v[54:57], v[94:97], v[38:41]
    ds_read_b64 v[138:139], v4 offset:3904
    ds_read_b64 v[140:141], v4 offset:3912
    ds_read_b128 v[170:173], v5 offset:320
    v_mfma_f32_16x16x32_bf16 v[38:41], v[58:61], v[90:93], v[38:41]
    v_mfma_f32_16x16x32_bf16 v[38:41], v[62:65], v[86:89], v[38:41]
    v_mfma_f32_16x16x32_bf16 v[38:41], v[66:69], v[82:85], v[38:41]
    v_mfma_f32_16x16x32_bf16 v[38:41], v[70:73], v[78:81], v[38:41]
    v_mfma_f32_16x16x32_bf16 v[42:45], v[46:49], v[106:109], v[42:45]
    v_mfma_f32_16x16x32_bf16 v[42:45], v[50:53], v[102:105], v[42:45]
    v_mfma_f32_16x16x32_bf16 v[42:45], v[54:57], v[98:101], v[42:45]
    v_mfma_f32_16x16x32_bf16 v[42:45], v[58:61], v[94:97], v[42:45]
    v_mfma_f32_16x16x32_bf16 v[42:45], v[62:65], v[90:93], v[42:45]
    v_mfma_f32_16x16x32_bf16 v[42:45], v[66:69], v[86:89], v[42:45]
    v_mfma_f32_16x16x32_bf16 v[42:45], v[70:73], v[82:85], v[42:45]
    v_mfma_f32_16x16x32_bf16 v[42:45], v[74:77], v[78:81], v[42:45]
    s_waitcnt lgkmcnt(0)
    v_mfma_f32_16x16x32_bf16 v[14:17], v[110:113], v[142:145], v[14:17]
    v_mfma_f32_16x16x32_bf16 v[18:21], v[110:113], v[146:149], v[18:21]
    v_mfma_f32_16x16x32_bf16 v[18:21], v[114:117], v[142:145], v[18:21]
    ds_read_b64 v[46:47], v4 offset:384
    ds_read_b64 v[48:49], v4 offset:392
    ds_read_b128 v[78:81], v5 offset:3968
    v_mfma_f32_16x16x32_bf16 v[22:25], v[110:113], v[150:153], v[22:25]
    v_mfma_f32_16x16x32_bf16 v[22:25], v[114:117], v[146:149], v[22:25]
    v_mfma_f32_16x16x32_bf16 v[22:25], v[118:121], v[142:145], v[22:25]
    ds_read_b64 v[50:51], v4 offset:896
    ds_read_b64 v[52:53], v4 offset:904
    ds_read_b128 v[82:85], v5 offset:3456
    v_mfma_f32_16x16x32_bf16 v[26:29], v[110:113], v[154:157], v[26:29]
    v_mfma_f32_16x16x32_bf16 v[26:29], v[114:117], v[150:153], v[26:29]
    v_mfma_f32_16x16x32_bf16 v[26:29], v[118:121], v[146:149], v[26:29]
    ds_read_b64 v[54:55], v4 offset:1408
    ds_read_b64 v[56:57], v4 offset:1416
    ds_read_b128 v[86:89], v5 offset:2944
    v_mfma_f32_16x16x32_bf16 v[26:29], v[122:125], v[142:145], v[26:29]
    v_mfma_f32_16x16x32_bf16 v[30:33], v[110:113], v[158:161], v[30:33]
    v_mfma_f32_16x16x32_bf16 v[30:33], v[114:117], v[154:157], v[30:33]
    ds_read_b64 v[58:59], v4 offset:1920
    ds_read_b64 v[60:61], v4 offset:1928
    ds_read_b128 v[90:93], v5 offset:2432
    v_mfma_f32_16x16x32_bf16 v[30:33], v[118:121], v[150:153], v[30:33]
    v_mfma_f32_16x16x32_bf16 v[30:33], v[122:125], v[146:149], v[30:33]
    v_mfma_f32_16x16x32_bf16 v[30:33], v[126:129], v[142:145], v[30:33]
    ds_read_b64 v[62:63], v4 offset:2432
    ds_read_b64 v[64:65], v4 offset:2440
    ds_read_b128 v[94:97], v5 offset:1920
    v_mfma_f32_16x16x32_bf16 v[34:37], v[110:113], v[162:165], v[34:37]
    v_mfma_f32_16x16x32_bf16 v[34:37], v[114:117], v[158:161], v[34:37]
    v_mfma_f32_16x16x32_bf16 v[34:37], v[118:121], v[154:157], v[34:37]
    ds_read_b64 v[66:67], v4 offset:2944
    ds_read_b64 v[68:69], v4 offset:2952
    ds_read_b128 v[98:101], v5 offset:1408
    v_mfma_f32_16x16x32_bf16 v[34:37], v[122:125], v[150:153], v[34:37]
    v_mfma_f32_16x16x32_bf16 v[34:37], v[126:129], v[146:149], v[34:37]
    v_mfma_f32_16x16x32_bf16 v[34:37], v[130:133], v[142:145], v[34:37]
    ds_read_b64 v[70:71], v4 offset:3456
    ds_read_b64 v[72:73], v4 offset:3464
    ds_read_b128 v[102:105], v5 offset:896
    v_mfma_f32_16x16x32_bf16 v[38:41], v[110:113], v[166:169], v[38:41]
    v_mfma_f32_16x16x32_bf16 v[38:41], v[114:117], v[162:165], v[38:41]
    v_mfma_f32_16x16x32_bf16 v[38:41], v[118:121], v[158:161], v[38:41]
    ds_read_b64 v[74:75], v4 offset:3968
    ds_read_b64 v[76:77], v4 offset:3976
    ds_read_b128 v[106:109], v5 offset:384
    v_mfma_f32_16x16x32_bf16 v[38:41], v[122:125], v[154:157], v[38:41]
    v_mfma_f32_16x16x32_bf16 v[38:41], v[126:129], v[150:153], v[38:41]
    v_mfma_f32_16x16x32_bf16 v[38:41], v[130:133], v[146:149], v[38:41]
    v_mfma_f32_16x16x32_bf16 v[38:41], v[134:137], v[142:145], v[38:41]
    v_mfma_f32_16x16x32_bf16 v[42:45], v[110:113], v[170:173], v[42:45]
    v_mfma_f32_16x16x32_bf16 v[42:45], v[114:117], v[166:169], v[42:45]
    v_mfma_f32_16x16x32_bf16 v[42:45], v[118:121], v[162:165], v[42:45]
    v_mfma_f32_16x16x32_bf16 v[42:45], v[122:125], v[158:161], v[42:45]
    v_mfma_f32_16x16x32_bf16 v[42:45], v[126:129], v[154:157], v[42:45]
    v_mfma_f32_16x16x32_bf16 v[42:45], v[130:133], v[150:153], v[42:45]
    v_mfma_f32_16x16x32_bf16 v[42:45], v[134:137], v[146:149], v[42:45]
    v_mfma_f32_16x16x32_bf16 v[42:45], v[138:141], v[142:145], v[42:45]
    s_waitcnt lgkmcnt(0)
    v_mfma_f32_16x16x32_bf16 v[14:17], v[46:49], v[78:81], v[14:17]
    v_mfma_f32_16x16x32_bf16 v[18:21], v[46:49], v[82:85], v[18:21]
    v_mfma_f32_16x16x32_bf16 v[18:21], v[50:53], v[78:81], v[18:21]
    ds_read_b64 v[110:111], v4 offset:448
    ds_read_b64 v[112:113], v4 offset:456
    ds_read_b128 v[142:145], v5 offset:4032
    v_mfma_f32_16x16x32_bf16 v[22:25], v[46:49], v[86:89], v[22:25]
    v_mfma_f32_16x16x32_bf16 v[22:25], v[50:53], v[82:85], v[22:25]
    v_mfma_f32_16x16x32_bf16 v[22:25], v[54:57], v[78:81], v[22:25]
    ds_read_b64 v[114:115], v4 offset:960
    ds_read_b64 v[116:117], v4 offset:968
    ds_read_b128 v[146:149], v5 offset:3520
    v_mfma_f32_16x16x32_bf16 v[26:29], v[46:49], v[90:93], v[26:29]
    v_mfma_f32_16x16x32_bf16 v[26:29], v[50:53], v[86:89], v[26:29]
    v_mfma_f32_16x16x32_bf16 v[26:29], v[54:57], v[82:85], v[26:29]
    ds_read_b64 v[118:119], v4 offset:1472
    ds_read_b64 v[120:121], v4 offset:1480
    ds_read_b128 v[150:153], v5 offset:3008
    v_mfma_f32_16x16x32_bf16 v[26:29], v[58:61], v[78:81], v[26:29]
    v_mfma_f32_16x16x32_bf16 v[30:33], v[46:49], v[94:97], v[30:33]
    v_mfma_f32_16x16x32_bf16 v[30:33], v[50:53], v[90:93], v[30:33]
    ds_read_b64 v[122:123], v4 offset:1984
    ds_read_b64 v[124:125], v4 offset:1992
    ds_read_b128 v[154:157], v5 offset:2496
    v_mfma_f32_16x16x32_bf16 v[30:33], v[54:57], v[86:89], v[30:33]
    v_mfma_f32_16x16x32_bf16 v[30:33], v[58:61], v[82:85], v[30:33]
    v_mfma_f32_16x16x32_bf16 v[30:33], v[62:65], v[78:81], v[30:33]
    ds_read_b64 v[126:127], v4 offset:2496
    ds_read_b64 v[128:129], v4 offset:2504
    ds_read_b128 v[158:161], v5 offset:1984
    v_mfma_f32_16x16x32_bf16 v[34:37], v[46:49], v[98:101], v[34:37]
    v_mfma_f32_16x16x32_bf16 v[34:37], v[50:53], v[94:97], v[34:37]
    v_mfma_f32_16x16x32_bf16 v[34:37], v[54:57], v[90:93], v[34:37]
    ds_read_b64 v[130:131], v4 offset:3008
    ds_read_b64 v[132:133], v4 offset:3016
    ds_read_b128 v[162:165], v5 offset:1472
    v_mfma_f32_16x16x32_bf16 v[34:37], v[58:61], v[86:89], v[34:37]
    v_mfma_f32_16x16x32_bf16 v[34:37], v[62:65], v[82:85], v[34:37]
    v_mfma_f32_16x16x32_bf16 v[34:37], v[66:69], v[78:81], v[34:37]
    ds_read_b64 v[134:135], v4 offset:3520
    ds_read_b64 v[136:137], v4 offset:3528
    ds_read_b128 v[166:169], v5 offset:960
    v_mfma_f32_16x16x32_bf16 v[38:41], v[46:49], v[102:105], v[38:41]
    v_mfma_f32_16x16x32_bf16 v[38:41], v[50:53], v[98:101], v[38:41]
    v_mfma_f32_16x16x32_bf16 v[38:41], v[54:57], v[94:97], v[38:41]
    ds_read_b64 v[138:139], v4 offset:4032
    ds_read_b64 v[140:141], v4 offset:4040
    ds_read_b128 v[170:173], v5 offset:448
    v_mfma_f32_16x16x32_bf16 v[38:41], v[58:61], v[90:93], v[38:41]
    v_mfma_f32_16x16x32_bf16 v[38:41], v[62:65], v[86:89], v[38:41]
    v_mfma_f32_16x16x32_bf16 v[38:41], v[66:69], v[82:85], v[38:41]
    v_mfma_f32_16x16x32_bf16 v[38:41], v[70:73], v[78:81], v[38:41]
    v_mfma_f32_16x16x32_bf16 v[42:45], v[46:49], v[106:109], v[42:45]
    v_mfma_f32_16x16x32_bf16 v[42:45], v[50:53], v[102:105], v[42:45]
    v_mfma_f32_16x16x32_bf16 v[42:45], v[54:57], v[98:101], v[42:45]
    v_mfma_f32_16x16x32_bf16 v[42:45], v[58:61], v[94:97], v[42:45]
    v_mfma_f32_16x16x32_bf16 v[42:45], v[62:65], v[90:93], v[42:45]
    v_mfma_f32_16x16x32_bf16 v[42:45], v[66:69], v[86:89], v[42:45]
    v_mfma_f32_16x16x32_bf16 v[42:45], v[70:73], v[82:85], v[42:45]
    v_mfma_f32_16x16x32_bf16 v[42:45], v[74:77], v[78:81], v[42:45]
    s_waitcnt lgkmcnt(0)
    v_mfma_f32_16x16x32_bf16 v[14:17], v[110:113], v[142:145], v[14:17]
    v_mfma_f32_16x16x32_bf16 v[18:21], v[110:113], v[146:149], v[18:21]
    v_mfma_f32_16x16x32_bf16 v[18:21], v[114:117], v[142:145], v[18:21]
    v_mfma_f32_16x16x32_bf16 v[22:25], v[110:113], v[150:153], v[22:25]
    v_mfma_f32_16x16x32_bf16 v[22:25], v[114:117], v[146:149], v[22:25]
    v_mfma_f32_16x16x32_bf16 v[22:25], v[118:121], v[142:145], v[22:25]
    v_mfma_f32_16x16x32_bf16 v[26:29], v[110:113], v[154:157], v[26:29]
    v_mfma_f32_16x16x32_bf16 v[26:29], v[114:117], v[150:153], v[26:29]
    v_mfma_f32_16x16x32_bf16 v[26:29], v[118:121], v[146:149], v[26:29]
    v_mfma_f32_16x16x32_bf16 v[26:29], v[122:125], v[142:145], v[26:29]
    v_mfma_f32_16x16x32_bf16 v[30:33], v[110:113], v[158:161], v[30:33]
    v_mfma_f32_16x16x32_bf16 v[30:33], v[114:117], v[154:157], v[30:33]
    v_mfma_f32_16x16x32_bf16 v[30:33], v[118:121], v[150:153], v[30:33]
    v_mfma_f32_16x16x32_bf16 v[30:33], v[122:125], v[146:149], v[30:33]
    v_mfma_f32_16x16x32_bf16 v[30:33], v[126:129], v[142:145], v[30:33]
    v_mfma_f32_16x16x32_bf16 v[34:37], v[110:113], v[162:165], v[34:37]
    v_mfma_f32_16x16x32_bf16 v[34:37], v[114:117], v[158:161], v[34:37]
    v_mfma_f32_16x16x32_bf16 v[34:37], v[118:121], v[154:157], v[34:37]
    v_mfma_f32_16x16x32_bf16 v[34:37], v[122:125], v[150:153], v[34:37]
    v_mfma_f32_16x16x32_bf16 v[34:37], v[126:129], v[146:149], v[34:37]
    v_mfma_f32_16x16x32_bf16 v[34:37], v[130:133], v[142:145], v[34:37]
    v_mfma_f32_16x16x32_bf16 v[38:41], v[110:113], v[166:169], v[38:41]
    v_mfma_f32_16x16x32_bf16 v[38:41], v[114:117], v[162:165], v[38:41]
    v_mfma_f32_16x16x32_bf16 v[38:41], v[118:121], v[158:161], v[38:41]
    v_mfma_f32_16x16x32_bf16 v[38:41], v[122:125], v[154:157], v[38:41]
    v_mfma_f32_16x16x32_bf16 v[38:41], v[126:129], v[150:153], v[38:41]
    v_mfma_f32_16x16x32_bf16 v[38:41], v[130:133], v[146:149], v[38:41]
    v_mfma_f32_16x16x32_bf16 v[38:41], v[134:137], v[142:145], v[38:41]
    v_mfma_f32_16x16x32_bf16 v[42:45], v[110:113], v[170:173], v[42:45]
    v_mfma_f32_16x16x32_bf16 v[42:45], v[114:117], v[166:169], v[42:45]
    v_mfma_f32_16x16x32_bf16 v[42:45], v[118:121], v[162:165], v[42:45]
    v_mfma_f32_16x16x32_bf16 v[42:45], v[122:125], v[158:161], v[42:45]
    v_mfma_f32_16x16x32_bf16 v[42:45], v[126:129], v[154:157], v[42:45]
    v_mfma_f32_16x16x32_bf16 v[42:45], v[130:133], v[150:153], v[42:45]
    v_mfma_f32_16x16x32_bf16 v[42:45], v[134:137], v[146:149], v[42:45]
    v_mfma_f32_16x16x32_bf16 v[42:45], v[138:141], v[142:145], v[42:45]
    v_lshlrev_b32 v8, 5, v2
    v_lshl_add_u32 v8, v3, 3, v8
    v_sub_u32 v8, s58, v8
    v_add_u32 v8, 17144, v8
    ds_read_b64 v[46:47], v8 offset:3584
    ds_read_b64 v[48:49], v8 offset:3072
    ds_read_b64 v[50:51], v8 offset:2560
    ds_read_b64 v[52:53], v8 offset:2048
    ds_read_b64 v[54:55], v8 offset:1536
    ds_read_b64 v[56:57], v8 offset:1024
    ds_read_b64 v[58:59], v8 offset:512
    ds_read_b64 v[60:61], v8 offset:0
    v_lshlrev_b32 v9, 5, v2
    v_lshl_add_u32 v9, v3, 3, v9
    v_add_u32 v9, s76, v9
    s_waitcnt vmcnt(0) lgkmcnt(0)
    v_lshlrev_b32 v7, 16, v7
    s_nop 4
    v_and_b32 v62, 0xffff0000, v47
    v_lshlrev_b32 v63, 16, v47
    v_and_b32 v64, 0xffff0000, v46
    v_lshlrev_b32 v65, 16, v46
    v_mul_f32 v62, v62, v7
    v_mul_f32 v63, v63, v7
    v_mul_f32 v64, v64, v7
    v_mul_f32 v65, v65, v7
    v_cvt_pk_bf16_f32 v66, v62, v63
    v_lshlrev_b32 v62, 16, v66
    v_and_b32 v63, 0xffff0000, v66
    v_cvt_pk_bf16_f32 v66, v64, v65
    v_lshlrev_b32 v64, 16, v66
    v_and_b32 v65, 0xffff0000, v66
    v_cvt_pk_bf16_f32 v66, v14, v15
    v_lshlrev_b32 v14, 16, v66
    v_and_b32 v15, 0xffff0000, v66
    v_cvt_pk_bf16_f32 v66, v16, v17
    v_lshlrev_b32 v16, 16, v66
    v_and_b32 v17, 0xffff0000, v66
    v_add_f32 v62, v62, v14
    v_add_f32 v63, v63, v15
    v_add_f32 v64, v64, v16
    v_add_f32 v65, v65, v17
    v_cvt_pk_bf16_f32 v68, v62, v63
    v_cvt_pk_bf16_f32 v69, v64, v65
    buffer_store_dwordx2 v[68:69], v9, s[72:75], 0 offen offset:0 sc1
    v_and_b32 v62, 0xffff0000, v49
    v_lshlrev_b32 v63, 16, v49
    v_and_b32 v64, 0xffff0000, v48
    v_lshlrev_b32 v65, 16, v48
    v_mul_f32 v62, v62, v7
    v_mul_f32 v63, v63, v7
    v_mul_f32 v64, v64, v7
    v_mul_f32 v65, v65, v7
    v_cvt_pk_bf16_f32 v66, v62, v63
    v_lshlrev_b32 v62, 16, v66
    v_and_b32 v63, 0xffff0000, v66
    v_cvt_pk_bf16_f32 v66, v64, v65
    v_lshlrev_b32 v64, 16, v66
    v_and_b32 v65, 0xffff0000, v66
    v_cvt_pk_bf16_f32 v66, v18, v19
    v_lshlrev_b32 v18, 16, v66
    v_and_b32 v19, 0xffff0000, v66
    v_cvt_pk_bf16_f32 v66, v20, v21
    v_lshlrev_b32 v20, 16, v66
    v_and_b32 v21, 0xffff0000, v66
    v_add_f32 v62, v62, v18
    v_add_f32 v63, v63, v19
    v_add_f32 v64, v64, v20
    v_add_f32 v65, v65, v21
    v_cvt_pk_bf16_f32 v70, v62, v63
    v_cvt_pk_bf16_f32 v71, v64, v65
    buffer_store_dwordx2 v[70:71], v9, s[72:75], 0 offen offset:512 sc1
    v_and_b32 v62, 0xffff0000, v51
    v_lshlrev_b32 v63, 16, v51
    v_and_b32 v64, 0xffff0000, v50
    v_lshlrev_b32 v65, 16, v50
    v_mul_f32 v62, v62, v7
    v_mul_f32 v63, v63, v7
    v_mul_f32 v64, v64, v7
    v_mul_f32 v65, v65, v7
    v_cvt_pk_bf16_f32 v66, v62, v63
    v_lshlrev_b32 v62, 16, v66
    v_and_b32 v63, 0xffff0000, v66
    v_cvt_pk_bf16_f32 v66, v64, v65
    v_lshlrev_b32 v64, 16, v66
    v_and_b32 v65, 0xffff0000, v66
    v_cvt_pk_bf16_f32 v66, v22, v23
    v_lshlrev_b32 v22, 16, v66
    v_and_b32 v23, 0xffff0000, v66
    v_cvt_pk_bf16_f32 v66, v24, v25
    v_lshlrev_b32 v24, 16, v66
    v_and_b32 v25, 0xffff0000, v66
    v_add_f32 v62, v62, v22
    v_add_f32 v63, v63, v23
    v_add_f32 v64, v64, v24
    v_add_f32 v65, v65, v25
    v_cvt_pk_bf16_f32 v72, v62, v63
    v_cvt_pk_bf16_f32 v73, v64, v65
    buffer_store_dwordx2 v[72:73], v9, s[72:75], 0 offen offset:1024 sc1
    v_and_b32 v62, 0xffff0000, v53
    v_lshlrev_b32 v63, 16, v53
    v_and_b32 v64, 0xffff0000, v52
    v_lshlrev_b32 v65, 16, v52
    v_mul_f32 v62, v62, v7
    v_mul_f32 v63, v63, v7
    v_mul_f32 v64, v64, v7
    v_mul_f32 v65, v65, v7
    v_cvt_pk_bf16_f32 v66, v62, v63
    v_lshlrev_b32 v62, 16, v66
    v_and_b32 v63, 0xffff0000, v66
    v_cvt_pk_bf16_f32 v66, v64, v65
    v_lshlrev_b32 v64, 16, v66
    v_and_b32 v65, 0xffff0000, v66
    v_cvt_pk_bf16_f32 v66, v26, v27
    v_lshlrev_b32 v26, 16, v66
    v_and_b32 v27, 0xffff0000, v66
    v_cvt_pk_bf16_f32 v66, v28, v29
    v_lshlrev_b32 v28, 16, v66
    v_and_b32 v29, 0xffff0000, v66
    v_add_f32 v62, v62, v26
    v_add_f32 v63, v63, v27
    v_add_f32 v64, v64, v28
    v_add_f32 v65, v65, v29
    v_cvt_pk_bf16_f32 v74, v62, v63
    v_cvt_pk_bf16_f32 v75, v64, v65
    buffer_store_dwordx2 v[74:75], v9, s[72:75], 0 offen offset:1536 sc1
    v_and_b32 v62, 0xffff0000, v55
    v_lshlrev_b32 v63, 16, v55
    v_and_b32 v64, 0xffff0000, v54
    v_lshlrev_b32 v65, 16, v54
    v_mul_f32 v62, v62, v7
    v_mul_f32 v63, v63, v7
    v_mul_f32 v64, v64, v7
    v_mul_f32 v65, v65, v7
    v_cvt_pk_bf16_f32 v66, v62, v63
    v_lshlrev_b32 v62, 16, v66
    v_and_b32 v63, 0xffff0000, v66
    v_cvt_pk_bf16_f32 v66, v64, v65
    v_lshlrev_b32 v64, 16, v66
    v_and_b32 v65, 0xffff0000, v66
    v_cvt_pk_bf16_f32 v66, v30, v31
    v_lshlrev_b32 v30, 16, v66
    v_and_b32 v31, 0xffff0000, v66
    v_cvt_pk_bf16_f32 v66, v32, v33
    v_lshlrev_b32 v32, 16, v66
    v_and_b32 v33, 0xffff0000, v66
    v_add_f32 v62, v62, v30
    v_add_f32 v63, v63, v31
    v_add_f32 v64, v64, v32
    v_add_f32 v65, v65, v33
    v_cvt_pk_bf16_f32 v76, v62, v63
    v_cvt_pk_bf16_f32 v77, v64, v65
    buffer_store_dwordx2 v[76:77], v9, s[72:75], 0 offen offset:2048 sc1
    v_and_b32 v62, 0xffff0000, v57
    v_lshlrev_b32 v63, 16, v57
    v_and_b32 v64, 0xffff0000, v56
    v_lshlrev_b32 v65, 16, v56
    v_mul_f32 v62, v62, v7
    v_mul_f32 v63, v63, v7
    v_mul_f32 v64, v64, v7
    v_mul_f32 v65, v65, v7
    v_cvt_pk_bf16_f32 v66, v62, v63
    v_lshlrev_b32 v62, 16, v66
    v_and_b32 v63, 0xffff0000, v66
    v_cvt_pk_bf16_f32 v66, v64, v65
    v_lshlrev_b32 v64, 16, v66
    v_and_b32 v65, 0xffff0000, v66
    v_cvt_pk_bf16_f32 v66, v34, v35
    v_lshlrev_b32 v34, 16, v66
    v_and_b32 v35, 0xffff0000, v66
    v_cvt_pk_bf16_f32 v66, v36, v37
    v_lshlrev_b32 v36, 16, v66
    v_and_b32 v37, 0xffff0000, v66
    v_add_f32 v62, v62, v34
    v_add_f32 v63, v63, v35
    v_add_f32 v64, v64, v36
    v_add_f32 v65, v65, v37
    v_cvt_pk_bf16_f32 v78, v62, v63
    v_cvt_pk_bf16_f32 v79, v64, v65
    buffer_store_dwordx2 v[78:79], v9, s[72:75], 0 offen offset:2560 sc1
    v_and_b32 v62, 0xffff0000, v59
    v_lshlrev_b32 v63, 16, v59
    v_and_b32 v64, 0xffff0000, v58
    v_lshlrev_b32 v65, 16, v58
    v_mul_f32 v62, v62, v7
    v_mul_f32 v63, v63, v7
    v_mul_f32 v64, v64, v7
    v_mul_f32 v65, v65, v7
    v_cvt_pk_bf16_f32 v66, v62, v63
    v_lshlrev_b32 v62, 16, v66
    v_and_b32 v63, 0xffff0000, v66
    v_cvt_pk_bf16_f32 v66, v64, v65
    v_lshlrev_b32 v64, 16, v66
    v_and_b32 v65, 0xffff0000, v66
    v_cvt_pk_bf16_f32 v66, v38, v39
    v_lshlrev_b32 v38, 16, v66
    v_and_b32 v39, 0xffff0000, v66
    v_cvt_pk_bf16_f32 v66, v40, v41
    v_lshlrev_b32 v40, 16, v66
    v_and_b32 v41, 0xffff0000, v66
    v_add_f32 v62, v62, v38
    v_add_f32 v63, v63, v39
    v_add_f32 v64, v64, v40
    v_add_f32 v65, v65, v41
    v_cvt_pk_bf16_f32 v80, v62, v63
    v_cvt_pk_bf16_f32 v81, v64, v65
    buffer_store_dwordx2 v[80:81], v9, s[72:75], 0 offen offset:3072 sc1
    v_and_b32 v62, 0xffff0000, v61
    v_lshlrev_b32 v63, 16, v61
    v_and_b32 v64, 0xffff0000, v60
    v_lshlrev_b32 v65, 16, v60
    v_mul_f32 v62, v62, v7
    v_mul_f32 v63, v63, v7
    v_mul_f32 v64, v64, v7
    v_mul_f32 v65, v65, v7
    v_cvt_pk_bf16_f32 v66, v62, v63
    v_lshlrev_b32 v62, 16, v66
    v_and_b32 v63, 0xffff0000, v66
    v_cvt_pk_bf16_f32 v66, v64, v65
    v_lshlrev_b32 v64, 16, v66
    v_and_b32 v65, 0xffff0000, v66
    v_cvt_pk_bf16_f32 v66, v42, v43
    v_lshlrev_b32 v42, 16, v66
    v_and_b32 v43, 0xffff0000, v66
    v_cvt_pk_bf16_f32 v66, v44, v45
    v_lshlrev_b32 v44, 16, v66
    v_and_b32 v45, 0xffff0000, v66
    v_add_f32 v62, v62, v42
    v_add_f32 v63, v63, v43
    v_add_f32 v64, v64, v44
    v_add_f32 v65, v65, v45
    v_cvt_pk_bf16_f32 v82, v62, v63
    v_cvt_pk_bf16_f32 v83, v64, v65
    buffer_store_dwordx2 v[82:83], v9, s[72:75], 0 offen offset:3584 sc1
    s_waitcnt vmcnt(0)
    v_mov_b32 v2, 163788
    v_mov_b32 v3, 1
    s_mov_b64 exec, 1
    ds_add_u32 v2, v3
    s_mov_b64 exec, -1
    s_cmp_lg_u32 s3, 0
    s_cbranch_scc1 Lcy
    v_mov_b32 v2, 163788
    s_mov_b32 s99, 0
    Lw4:
    ds_read_b32 v3, v2
    s_waitcnt lgkmcnt(0)
    v_readfirstlane_b32 s5, v3
    s_add_u32 s99, s99, 1
    s_cmp_ge_u32 s99, 0x400000
    s_cbranch_scc1 Lw4_done
    s_cmp_lt_u32 s5, 4
    s_cbranch_scc1 Lw4
    Lw4_done:
    s_lshr_b32 s12, s2, 4
    s_lshl_b32 s5, s12, 8
    s_add_u32 s5, s5, 8192
    v_mov_b32 v2, s5
    v_mov_b32 v3, 1
    s_mov_b64 exec, 1
    buffer_atomic_add v3, v2, s[8:11], 0 offen sc1
    s_mov_b64 exec, -1
Lcy:
    s_load_dwordx4 s[28:31], s[0:1], 72
    s_load_dwordx2 s[32:33], s[0:1], 96
    s_lshl_b32 s24, s6, 18
    s_lshl_b32 s25, s7, 7
    s_waitcnt lgkmcnt(0)
    s_add_u32 s12, s32, 12582912
    s_addc_u32 s13, s33, 0
    s_mov_b32 s14, 4194304
    s_mov_b32 s15, 0x00020000
    s_mov_b32 s16, s28
    s_mov_b32 s17, s29
    s_mov_b32 s18, 2097152
    s_mov_b32 s19, 0x00020000
    s_mov_b32 s20, s30
    s_mov_b32 s21, s31
    s_mov_b32 s22, 8388608
    s_mov_b32 s23, 0x00020000
    s_lshl_b32 s52, s2, 2
    s_add_u32 s52, s52, s3
    v_and_b32 v5, 31, v0
    v_lshrrev_b32 v6, 1, v5
    v_and_b32 v6, 7, v6
    v_lshrrev_b32 v7, 5, v0
    v_xor_b32 v6, v6, v7
    s_bfe_u32 s36, s3, 0x10001
    s_lshl_b32 s36, s36, 13
    s_add_u32 s36, s36, 84992
    v_lshlrev_b32 v5, 7, v5
    v_add_u32 v5, s36, v5
    v_xor_b32 v8, 0, v6
    v_lshl_add_u32 v8, v8, 4, v5
    v_add_u32 v12, 24576, v8
    v_add_u32 v16, 49152, v8
    v_xor_b32 v9, 2, v6
    v_lshl_add_u32 v9, v9, 4, v5
    v_add_u32 v13, 24576, v9
    v_add_u32 v17, 49152, v9
    v_xor_b32 v10, 4, v6
    v_lshl_add_u32 v10, v10, 4, v5
    v_add_u32 v14, 24576, v10
    v_add_u32 v18, 49152, v10
    v_xor_b32 v11, 6, v6
    v_lshl_add_u32 v11, v11, 4, v5
    v_add_u32 v15, 24576, v11
    v_add_u32 v19, 49152, v11
    v_lshrrev_b32 v5, 4, v0
    v_and_b32 v6, 1, v5
    v_lshlrev_b32 v6, 1, v6
    v_bfe_u32 v7, v0, 1, 1
    v_add_u32 v6, v6, v7
    s_and_b32 s36, s3, 1
    s_lshl_b32 s36, s36, 2
    v_add_u32 v6, s36, v6
    v_bfe_u32 v7, v0, 3, 1
    v_lshlrev_b32 v7, 2, v7
    v_xor_b32 v6, v6, v7
    v_lshlrev_b32 v20, 4, v6
    v_and_b32 v6, 1, v0
    v_lshl_add_u32 v20, v6, 3, v20
    v_lshrrev_b32 v5, 1, v5
    v_lshlrev_b32 v5, 3, v5
    v_bfe_u32 v6, v0, 2, 2
    v_add_u32 v5, v5, v6
    v_lshl_add_u32 v20, v5, 7, v20
    v_add_u32 v20, 84992, v20
    v_add_u32 v21, 24576, v20
    v_add_u32 v22, 49152, v20
    v_mov_b32 v48, 0
    v_mov_b32 v49, 0
    v_mov_b32 v50, 0
    v_mov_b32 v51, 0
    v_mov_b32 v52, 0
    v_mov_b32 v53, 0
    v_mov_b32 v54, 0
    v_mov_b32 v55, 0
    v_mov_b32 v56, 0
    v_mov_b32 v57, 0
    v_mov_b32 v58, 0
    v_mov_b32 v59, 0
    v_mov_b32 v60, 0
    v_mov_b32 v61, 0
    v_mov_b32 v62, 0
    v_mov_b32 v63, 0
    v_mov_b32 v64, 0
    v_mov_b32 v65, 0
    v_mov_b32 v66, 0
    v_mov_b32 v67, 0
    v_mov_b32 v68, 0
    v_mov_b32 v69, 0
    v_mov_b32 v70, 0
    v_mov_b32 v71, 0
    v_mov_b32 v72, 0
    v_mov_b32 v73, 0
    v_mov_b32 v74, 0
    v_mov_b32 v75, 0
    v_mov_b32 v76, 0
    v_mov_b32 v77, 0
    v_mov_b32 v78, 0
    v_mov_b32 v79, 0
    s_barrier
    ds_read_b128 v[24:27], v8 offset:0
    ds_read_b128 v[28:31], v8 offset:4096
    ds_read_b64_tr_b16 v[32:33], v20 offset:16384
    ds_read_b64_tr_b16 v[34:35], v20 offset:16896
    s_waitcnt lgkmcnt(0)
    v_mfma_f32_32x32x16_bf16 v[48:63], v[32:35], v[24:27], v[48:63]
    ds_read_b128 v[36:39], v9 offset:0
    ds_read_b128 v[40:43], v9 offset:4096
    ds_read_b64_tr_b16 v[44:45], v20 offset:18432
    ds_read_b64_tr_b16 v[46:47], v20 offset:18944
    v_mfma_f32_32x32x16_bf16 v[64:79], v[32:35], v[28:31], v[64:79]
    s_waitcnt lgkmcnt(0)
    v_mfma_f32_32x32x16_bf16 v[48:63], v[44:47], v[36:39], v[48:63]
    ds_read_b128 v[24:27], v10 offset:0
    ds_read_b128 v[28:31], v10 offset:4096
    ds_read_b64_tr_b16 v[32:33], v20 offset:20480
    ds_read_b64_tr_b16 v[34:35], v20 offset:20992
    v_mfma_f32_32x32x16_bf16 v[64:79], v[44:47], v[40:43], v[64:79]
    s_waitcnt lgkmcnt(0)
    v_mfma_f32_32x32x16_bf16 v[48:63], v[32:35], v[24:27], v[48:63]
    ds_read_b128 v[36:39], v11 offset:0
    ds_read_b128 v[40:43], v11 offset:4096
    ds_read_b64_tr_b16 v[44:45], v20 offset:22528
    ds_read_b64_tr_b16 v[46:47], v20 offset:23040
    v_mfma_f32_32x32x16_bf16 v[64:79], v[32:35], v[28:31], v[64:79]
    s_waitcnt lgkmcnt(0)
    s_barrier
    v_mfma_f32_32x32x16_bf16 v[48:63], v[44:47], v[36:39], v[48:63]
    ds_read_b128 v[24:27], v12 offset:0
    ds_read_b128 v[28:31], v12 offset:4096
    ds_read_b64_tr_b16 v[32:33], v21 offset:16384
    ds_read_b64_tr_b16 v[34:35], v21 offset:16896
    v_mfma_f32_32x32x16_bf16 v[64:79], v[44:47], v[40:43], v[64:79]
    s_waitcnt lgkmcnt(0)
    v_mfma_f32_32x32x16_bf16 v[48:63], v[32:35], v[24:27], v[48:63]
    ds_read_b128 v[36:39], v13 offset:0
    ds_read_b128 v[40:43], v13 offset:4096
    ds_read_b64_tr_b16 v[44:45], v21 offset:18432
    ds_read_b64_tr_b16 v[46:47], v21 offset:18944
    s_load_dwordx2 s[68:69], s[0:1], 0
    s_load_dwordx2 s[70:71], s[0:1], 80
    s_load_dwordx2 s[74:75], s[0:1], 96
    s_lshr_b32 s76, s52, 4
    s_and_b32 s77, s52, 15
    s_lshl_b32 s76, s76, 5
    v_mfma_f32_32x32x16_bf16 v[64:79], v[32:35], v[28:31], v[64:79]
    s_lshl_b32 s77, s77, 6
    v_and_b32 v105, 7, v0
    v_lshlrev_b32 v105, 3, v105
    v_add_u32 v105, s77, v105
    v_lshrrev_b32 v104, 3, v0
    v_lshlrev_b32 v104, 2, v104
    s_waitcnt lgkmcnt(0)
    v_mfma_f32_32x32x16_bf16 v[48:63], v[44:47], v[36:39], v[48:63]
    ds_read_b128 v[24:27], v14 offset:0
    ds_read_b128 v[28:31], v14 offset:4096
    ds_read_b64_tr_b16 v[32:33], v21 offset:20480
    ds_read_b64_tr_b16 v[34:35], v21 offset:20992
    v_add_u32 v104, s76, v104
    v_lshlrev_b32 v106, 11, v104
    v_lshl_add_u32 v106, v105, 1, v106
    v_lshlrev_b32 v108, 12, v104
    v_lshl_add_u32 v108, v105, 1, v108
    v_lshlrev_b32 v107, 12, v105
    v_mfma_f32_32x32x16_bf16 v[64:79], v[44:47], v[40:43], v[64:79]
    v_lshl_add_u32 v107, v104, 1, v107
    s_waitcnt lgkmcnt(0)
    s_mov_b32 s56, s68
    s_mov_b32 s57, s69
    s_mov_b32 s58, 4194304
    s_mov_b32 s59, 0x00020000
    s_waitcnt lgkmcnt(0)
    v_mfma_f32_32x32x16_bf16 v[48:63], v[32:35], v[24:27], v[48:63]
    ds_read_b128 v[36:39], v15 offset:0
    ds_read_b128 v[40:43], v15 offset:4096
    ds_read_b64_tr_b16 v[44:45], v21 offset:22528
    ds_read_b64_tr_b16 v[46:47], v21 offset:23040
    s_mov_b32 s64, s70
    s_mov_b32 s65, s71
    s_mov_b32 s66, 8388608
    s_mov_b32 s67, 0x00020000
    s_add_u32 s60, s74, 4194304
    s_addc_u32 s61, s75, 0
    v_mfma_f32_32x32x16_bf16 v[64:79], v[32:35], v[28:31], v[64:79]
    s_mov_b32 s62, 4194304
    s_mov_b32 s63, 0x00020000
    s_mov_b32 s78, 0
    buffer_load_dwordx4 v[112:115], v106, s[56:59], s78 offen
    s_mov_b32 s78, 2048
    buffer_load_dwordx4 v[116:119], v106, s[56:59], s78 offen
    s_waitcnt lgkmcnt(0)
    s_barrier
    v_mfma_f32_32x32x16_bf16 v[48:63], v[44:47], v[36:39], v[48:63]
    ds_read_b128 v[24:27], v16 offset:0
    ds_read_b128 v[28:31], v16 offset:4096
    ds_read_b64_tr_b16 v[32:33], v22 offset:16384
    ds_read_b64_tr_b16 v[34:35], v22 offset:16896
    s_mov_b32 s78, 4096
    buffer_load_dwordx4 v[120:123], v106, s[56:59], s78 offen
    s_mov_b32 s78, 6144
    buffer_load_dwordx4 v[124:127], v106, s[56:59], s78 offen
    v_mfma_f32_32x32x16_bf16 v[64:79], v[44:47], v[40:43], v[64:79]
    s_waitcnt lgkmcnt(0)
    v_mfma_f32_32x32x16_bf16 v[48:63], v[32:35], v[24:27], v[48:63]
    ds_read_b128 v[36:39], v17 offset:0
    ds_read_b128 v[40:43], v17 offset:4096
    ds_read_b64_tr_b16 v[44:45], v22 offset:18432
    ds_read_b64_tr_b16 v[46:47], v22 offset:18944
    v_mfma_f32_32x32x16_bf16 v[64:79], v[32:35], v[28:31], v[64:79]
    s_waitcnt lgkmcnt(0)
    v_mfma_f32_32x32x16_bf16 v[48:63], v[44:47], v[36:39], v[48:63]
    ds_read_b128 v[24:27], v18 offset:0
    ds_read_b128 v[28:31], v18 offset:4096
    ds_read_b64_tr_b16 v[32:33], v22 offset:20480
    ds_read_b64_tr_b16 v[34:35], v22 offset:20992
    v_mfma_f32_32x32x16_bf16 v[64:79], v[44:47], v[40:43], v[64:79]
    s_waitcnt lgkmcnt(0)
    v_mfma_f32_32x32x16_bf16 v[48:63], v[32:35], v[24:27], v[48:63]
    ds_read_b128 v[36:39], v19 offset:0
    ds_read_b128 v[40:43], v19 offset:4096
    ds_read_b64_tr_b16 v[44:45], v22 offset:22528
    ds_read_b64_tr_b16 v[46:47], v22 offset:23040
    v_mfma_f32_32x32x16_bf16 v[64:79], v[32:35], v[28:31], v[64:79]
    s_waitcnt lgkmcnt(0)
    s_barrier
    v_mfma_f32_32x32x16_bf16 v[48:63], v[44:47], v[36:39], v[48:63]
    ds_read_b128 v[24:27], v8 offset:0
    ds_read_b128 v[28:31], v8 offset:4096
    ds_read_b64_tr_b16 v[32:33], v20 offset:16384
    ds_read_b64_tr_b16 v[34:35], v20 offset:16896
    v_mfma_f32_32x32x16_bf16 v[64:79], v[44:47], v[40:43], v[64:79]
    s_waitcnt lgkmcnt(0)
    v_mfma_f32_32x32x16_bf16 v[48:63], v[32:35], v[24:27], v[48:63]
    ds_read_b128 v[36:39], v9 offset:0
    ds_read_b128 v[40:43], v9 offset:4096
    ds_read_b64_tr_b16 v[44:45], v20 offset:18432
    ds_read_b64_tr_b16 v[46:47], v20 offset:18944
    v_mfma_f32_32x32x16_bf16 v[64:79], v[32:35], v[28:31], v[64:79]
    s_waitcnt lgkmcnt(0)
    v_mfma_f32_32x32x16_bf16 v[48:63], v[44:47], v[36:39], v[48:63]
    ds_read_b128 v[24:27], v10 offset:0
    ds_read_b128 v[28:31], v10 offset:4096
    ds_read_b64_tr_b16 v[32:33], v20 offset:20480
    ds_read_b64_tr_b16 v[34:35], v20 offset:20992
    v_mfma_f32_32x32x16_bf16 v[64:79], v[44:47], v[40:43], v[64:79]
    s_waitcnt lgkmcnt(0)
    v_mfma_f32_32x32x16_bf16 v[48:63], v[32:35], v[24:27], v[48:63]
    ds_read_b128 v[36:39], v11 offset:0
    ds_read_b128 v[40:43], v11 offset:4096
    ds_read_b64_tr_b16 v[44:45], v20 offset:22528
    ds_read_b64_tr_b16 v[46:47], v20 offset:23040
    v_mfma_f32_32x32x16_bf16 v[64:79], v[32:35], v[28:31], v[64:79]
    s_waitcnt lgkmcnt(0)
    s_barrier
    v_mfma_f32_32x32x16_bf16 v[48:63], v[44:47], v[36:39], v[48:63]
    ds_read_b128 v[24:27], v12 offset:0
    ds_read_b128 v[28:31], v12 offset:4096
    ds_read_b64_tr_b16 v[32:33], v21 offset:16384
    ds_read_b64_tr_b16 v[34:35], v21 offset:16896
    v_mfma_f32_32x32x16_bf16 v[64:79], v[44:47], v[40:43], v[64:79]
    s_waitcnt lgkmcnt(0)
    v_mfma_f32_32x32x16_bf16 v[48:63], v[32:35], v[24:27], v[48:63]
    ds_read_b128 v[36:39], v13 offset:0
    ds_read_b128 v[40:43], v13 offset:4096
    ds_read_b64_tr_b16 v[44:45], v21 offset:18432
    ds_read_b64_tr_b16 v[46:47], v21 offset:18944
    v_mfma_f32_32x32x16_bf16 v[64:79], v[32:35], v[28:31], v[64:79]
    s_waitcnt lgkmcnt(0)
    v_mfma_f32_32x32x16_bf16 v[48:63], v[44:47], v[36:39], v[48:63]
    ds_read_b128 v[24:27], v14 offset:0
    ds_read_b128 v[28:31], v14 offset:4096
    ds_read_b64_tr_b16 v[32:33], v21 offset:20480
    ds_read_b64_tr_b16 v[34:35], v21 offset:20992
    v_mfma_f32_32x32x16_bf16 v[64:79], v[44:47], v[40:43], v[64:79]
    s_waitcnt lgkmcnt(0)
    v_mfma_f32_32x32x16_bf16 v[48:63], v[32:35], v[24:27], v[48:63]
    ds_read_b128 v[36:39], v15 offset:0
    ds_read_b128 v[40:43], v15 offset:4096
    ds_read_b64_tr_b16 v[44:45], v21 offset:22528
    ds_read_b64_tr_b16 v[46:47], v21 offset:23040
    v_mfma_f32_32x32x16_bf16 v[64:79], v[32:35], v[28:31], v[64:79]
    s_waitcnt lgkmcnt(0)
    s_barrier
    v_mfma_f32_32x32x16_bf16 v[48:63], v[44:47], v[36:39], v[48:63]
    ds_read_b128 v[24:27], v16 offset:0
    ds_read_b128 v[28:31], v16 offset:4096
    ds_read_b64_tr_b16 v[32:33], v22 offset:16384
    ds_read_b64_tr_b16 v[34:35], v22 offset:16896
    v_mfma_f32_32x32x16_bf16 v[64:79], v[44:47], v[40:43], v[64:79]
    s_waitcnt lgkmcnt(0)
    v_mfma_f32_32x32x16_bf16 v[48:63], v[32:35], v[24:27], v[48:63]
    ds_read_b128 v[36:39], v17 offset:0
    ds_read_b128 v[40:43], v17 offset:4096
    ds_read_b64_tr_b16 v[44:45], v22 offset:18432
    ds_read_b64_tr_b16 v[46:47], v22 offset:18944
    s_and_b32 s53, s52, 15
    s_lshl_b32 s5, s53, 8
    s_add_u32 s5, s5, 8192
    v_mov_b32 v100, s5
    buffer_load_dword v101, v100, s[8:11], 0 offen sc1
    v_mfma_f32_32x32x16_bf16 v[64:79], v[32:35], v[28:31], v[64:79]
    s_waitcnt lgkmcnt(0)
    v_mfma_f32_32x32x16_bf16 v[48:63], v[44:47], v[36:39], v[48:63]
    ds_read_b128 v[24:27], v18 offset:0
    ds_read_b128 v[28:31], v18 offset:4096
    ds_read_b64_tr_b16 v[32:33], v22 offset:20480
    ds_read_b64_tr_b16 v[34:35], v22 offset:20992
    v_mfma_f32_32x32x16_bf16 v[64:79], v[44:47], v[40:43], v[64:79]
    s_waitcnt lgkmcnt(0)
    v_mfma_f32_32x32x16_bf16 v[48:63], v[32:35], v[24:27], v[48:63]
    ds_read_b128 v[36:39], v19 offset:0
    ds_read_b128 v[40:43], v19 offset:4096
    ds_read_b64_tr_b16 v[44:45], v22 offset:22528
    ds_read_b64_tr_b16 v[46:47], v22 offset:23040
    v_mfma_f32_32x32x16_bf16 v[64:79], v[32:35], v[28:31], v[64:79]
    s_waitcnt lgkmcnt(0)
    s_barrier
    v_mfma_f32_32x32x16_bf16 v[48:63], v[44:47], v[36:39], v[48:63]
    ds_read_b128 v[24:27], v8 offset:0
    ds_read_b128 v[28:31], v8 offset:4096
    ds_read_b64_tr_b16 v[32:33], v20 offset:16384
    ds_read_b64_tr_b16 v[34:35], v20 offset:16896
    v_mfma_f32_32x32x16_bf16 v[64:79], v[44:47], v[40:43], v[64:79]
    s_waitcnt lgkmcnt(0)
    v_mfma_f32_32x32x16_bf16 v[48:63], v[32:35], v[24:27], v[48:63]
    ds_read_b128 v[36:39], v9 offset:0
    ds_read_b128 v[40:43], v9 offset:4096
    ds_read_b64_tr_b16 v[44:45], v20 offset:18432
    ds_read_b64_tr_b16 v[46:47], v20 offset:18944
    v_mfma_f32_32x32x16_bf16 v[64:79], v[32:35], v[28:31], v[64:79]
    s_waitcnt lgkmcnt(0)
    v_mfma_f32_32x32x16_bf16 v[48:63], v[44:47], v[36:39], v[48:63]
    ds_read_b128 v[24:27], v10 offset:0
    ds_read_b128 v[28:31], v10 offset:4096
    ds_read_b64_tr_b16 v[32:33], v20 offset:20480
    ds_read_b64_tr_b16 v[34:35], v20 offset:20992
    v_mfma_f32_32x32x16_bf16 v[64:79], v[44:47], v[40:43], v[64:79]
    s_waitcnt lgkmcnt(0)
    v_mfma_f32_32x32x16_bf16 v[48:63], v[32:35], v[24:27], v[48:63]
    ds_read_b128 v[36:39], v11 offset:0
    ds_read_b128 v[40:43], v11 offset:4096
    ds_read_b64_tr_b16 v[44:45], v20 offset:22528
    ds_read_b64_tr_b16 v[46:47], v20 offset:23040
    v_mfma_f32_32x32x16_bf16 v[64:79], v[32:35], v[28:31], v[64:79]
    s_waitcnt lgkmcnt(0)
    s_barrier
    v_mfma_f32_32x32x16_bf16 v[48:63], v[44:47], v[36:39], v[48:63]
    ds_read_b128 v[24:27], v12 offset:0
    ds_read_b128 v[28:31], v12 offset:4096
    ds_read_b64_tr_b16 v[32:33], v21 offset:16384
    ds_read_b64_tr_b16 v[34:35], v21 offset:16896
    v_mfma_f32_32x32x16_bf16 v[64:79], v[44:47], v[40:43], v[64:79]
    s_waitcnt lgkmcnt(0)
    v_mfma_f32_32x32x16_bf16 v[48:63], v[32:35], v[24:27], v[48:63]
    ds_read_b128 v[36:39], v13 offset:0
    ds_read_b128 v[40:43], v13 offset:4096
    ds_read_b64_tr_b16 v[44:45], v21 offset:18432
    ds_read_b64_tr_b16 v[46:47], v21 offset:18944
    s_waitcnt vmcnt(0)
    v_readfirstlane_b32 s5, v101
    s_nop 3
    s_cmp_ge_u32 s5, 16
    s_cbranch_scc1 Lpoll_y_done
    s_lshl_b32 s5, s53, 8
    s_add_u32 s5, s5, 8192
    v_mov_b32 v100, s5
    s_mov_b32 s99, 0
    Lpoll_y:
    buffer_load_dword v101, v100, s[8:11], 0 offen sc1
    s_waitcnt vmcnt(0)
    v_readfirstlane_b32 s5, v101
    s_nop 3
    s_cmp_ge_u32 s5, 16
    s_cbranch_scc1 Lpoll_y_done
    s_sleep 2
    s_add_u32 s99, s99, 1
    s_cmp_lt_u32 s99, 0x40000
    s_cbranch_scc1 Lpoll_y
    Lpoll_y_done:
    v_mfma_f32_32x32x16_bf16 v[64:79], v[32:35], v[28:31], v[64:79]
    s_waitcnt lgkmcnt(0)
    v_mfma_f32_32x32x16_bf16 v[48:63], v[44:47], v[36:39], v[48:63]
    ds_read_b128 v[24:27], v14 offset:0
    ds_read_b128 v[28:31], v14 offset:4096
    ds_read_b64_tr_b16 v[32:33], v21 offset:20480
    ds_read_b64_tr_b16 v[34:35], v21 offset:20992
    v_mfma_f32_32x32x16_bf16 v[64:79], v[44:47], v[40:43], v[64:79]
    s_waitcnt lgkmcnt(0)
    v_mfma_f32_32x32x16_bf16 v[48:63], v[32:35], v[24:27], v[48:63]
    ds_read_b128 v[36:39], v15 offset:0
    ds_read_b128 v[40:43], v15 offset:4096
    ds_read_b64_tr_b16 v[44:45], v21 offset:22528
    ds_read_b64_tr_b16 v[46:47], v21 offset:23040
    v_mfma_f32_32x32x16_bf16 v[64:79], v[32:35], v[28:31], v[64:79]
    s_waitcnt lgkmcnt(0)
    s_barrier
    v_mfma_f32_32x32x16_bf16 v[48:63], v[44:47], v[36:39], v[48:63]
    ds_read_b128 v[24:27], v16 offset:0
    ds_read_b128 v[28:31], v16 offset:4096
    ds_read_b64_tr_b16 v[32:33], v22 offset:16384
    ds_read_b64_tr_b16 v[34:35], v22 offset:16896
    v_mfma_f32_32x32x16_bf16 v[64:79], v[44:47], v[40:43], v[64:79]
    s_waitcnt lgkmcnt(0)
    v_mfma_f32_32x32x16_bf16 v[48:63], v[32:35], v[24:27], v[48:63]
    ds_read_b128 v[36:39], v17 offset:0
    ds_read_b128 v[40:43], v17 offset:4096
    ds_read_b64_tr_b16 v[44:45], v22 offset:18432
    ds_read_b64_tr_b16 v[46:47], v22 offset:18944
    v_mfma_f32_32x32x16_bf16 v[64:79], v[32:35], v[28:31], v[64:79]
    s_waitcnt lgkmcnt(0)
    v_mfma_f32_32x32x16_bf16 v[48:63], v[44:47], v[36:39], v[48:63]
    ds_read_b128 v[24:27], v18 offset:0
    ds_read_b128 v[28:31], v18 offset:4096
    ds_read_b64_tr_b16 v[32:33], v22 offset:20480
    ds_read_b64_tr_b16 v[34:35], v22 offset:20992
    v_mfma_f32_32x32x16_bf16 v[64:79], v[44:47], v[40:43], v[64:79]
    s_waitcnt lgkmcnt(0)
    v_mfma_f32_32x32x16_bf16 v[48:63], v[32:35], v[24:27], v[48:63]
    ds_read_b128 v[36:39], v19 offset:0
    ds_read_b128 v[40:43], v19 offset:4096
    ds_read_b64_tr_b16 v[44:45], v22 offset:22528
    ds_read_b64_tr_b16 v[46:47], v22 offset:23040
    v_mfma_f32_32x32x16_bf16 v[64:79], v[32:35], v[28:31], v[64:79]
    s_waitcnt lgkmcnt(0)
    s_barrier
    v_mfma_f32_32x32x16_bf16 v[48:63], v[44:47], v[36:39], v[48:63]
    ds_read_b128 v[24:27], v8 offset:0
    ds_read_b128 v[28:31], v8 offset:4096
    ds_read_b64_tr_b16 v[32:33], v20 offset:16384
    ds_read_b64_tr_b16 v[34:35], v20 offset:16896
    v_mfma_f32_32x32x16_bf16 v[64:79], v[44:47], v[40:43], v[64:79]
    s_waitcnt lgkmcnt(0)
    v_mfma_f32_32x32x16_bf16 v[48:63], v[32:35], v[24:27], v[48:63]
    ds_read_b128 v[36:39], v9 offset:0
    ds_read_b128 v[40:43], v9 offset:4096
    ds_read_b64_tr_b16 v[44:45], v20 offset:18432
    ds_read_b64_tr_b16 v[46:47], v20 offset:18944
    v_mfma_f32_32x32x16_bf16 v[64:79], v[32:35], v[28:31], v[64:79]
    s_waitcnt lgkmcnt(0)
    v_mfma_f32_32x32x16_bf16 v[48:63], v[44:47], v[36:39], v[48:63]
    ds_read_b128 v[24:27], v10 offset:0
    ds_read_b128 v[28:31], v10 offset:4096
    ds_read_b64_tr_b16 v[32:33], v20 offset:20480
    ds_read_b64_tr_b16 v[34:35], v20 offset:20992
    v_mfma_f32_32x32x16_bf16 v[64:79], v[44:47], v[40:43], v[64:79]
    s_waitcnt lgkmcnt(0)
    v_mfma_f32_32x32x16_bf16 v[48:63], v[32:35], v[24:27], v[48:63]
    ds_read_b128 v[36:39], v11 offset:0
    ds_read_b128 v[40:43], v11 offset:4096
    ds_read_b64_tr_b16 v[44:45], v20 offset:22528
    ds_read_b64_tr_b16 v[46:47], v20 offset:23040
    v_mfma_f32_32x32x16_bf16 v[64:79], v[32:35], v[28:31], v[64:79]
    s_waitcnt lgkmcnt(0)
    s_barrier
    v_mfma_f32_32x32x16_bf16 v[48:63], v[44:47], v[36:39], v[48:63]
    ds_read_b128 v[24:27], v12 offset:0
    ds_read_b128 v[28:31], v12 offset:4096
    ds_read_b64_tr_b16 v[32:33], v21 offset:16384
    ds_read_b64_tr_b16 v[34:35], v21 offset:16896
    v_mfma_f32_32x32x16_bf16 v[64:79], v[44:47], v[40:43], v[64:79]
    s_waitcnt lgkmcnt(0)
    v_mfma_f32_32x32x16_bf16 v[48:63], v[32:35], v[24:27], v[48:63]
    ds_read_b128 v[36:39], v13 offset:0
    ds_read_b128 v[40:43], v13 offset:4096
    ds_read_b64_tr_b16 v[44:45], v21 offset:18432
    ds_read_b64_tr_b16 v[46:47], v21 offset:18944
    s_mov_b32 s79, 0
    buffer_load_dwordx2 v[128:129], v107, s[60:63], s79 offen sc1
    s_mov_b32 s79, 4096
    buffer_load_dwordx2 v[130:131], v107, s[60:63], s79 offen sc1
    s_mov_b32 s79, 8192
    buffer_load_dwordx2 v[132:133], v107, s[60:63], s79 offen sc1
    v_mfma_f32_32x32x16_bf16 v[64:79], v[32:35], v[28:31], v[64:79]
    s_mov_b32 s79, 12288
    buffer_load_dwordx2 v[134:135], v107, s[60:63], s79 offen sc1
    s_mov_b32 s79, 16384
    buffer_load_dwordx2 v[136:137], v107, s[60:63], s79 offen sc1
    s_mov_b32 s79, 20480
    buffer_load_dwordx2 v[138:139], v107, s[60:63], s79 offen sc1
    s_waitcnt lgkmcnt(0)
    v_mfma_f32_32x32x16_bf16 v[48:63], v[44:47], v[36:39], v[48:63]
    ds_read_b128 v[24:27], v14 offset:0
    ds_read_b128 v[28:31], v14 offset:4096
    ds_read_b64_tr_b16 v[32:33], v21 offset:20480
    ds_read_b64_tr_b16 v[34:35], v21 offset:20992
    s_mov_b32 s79, 24576
    buffer_load_dwordx2 v[140:141], v107, s[60:63], s79 offen sc1
    s_mov_b32 s79, 28672
    buffer_load_dwordx2 v[142:143], v107, s[60:63], s79 offen sc1
    v_mfma_f32_32x32x16_bf16 v[64:79], v[44:47], v[40:43], v[64:79]
    s_waitcnt lgkmcnt(0)
    v_mfma_f32_32x32x16_bf16 v[48:63], v[32:35], v[24:27], v[48:63]
    ds_read_b128 v[36:39], v15 offset:0
    ds_read_b128 v[40:43], v15 offset:4096
    ds_read_b64_tr_b16 v[44:45], v21 offset:22528
    ds_read_b64_tr_b16 v[46:47], v21 offset:23040
    v_mfma_f32_32x32x16_bf16 v[64:79], v[32:35], v[28:31], v[64:79]
    s_waitcnt lgkmcnt(0)
    s_barrier
    v_mfma_f32_32x32x16_bf16 v[48:63], v[44:47], v[36:39], v[48:63]
    ds_read_b128 v[24:27], v16 offset:0
    ds_read_b128 v[28:31], v16 offset:4096
    ds_read_b64_tr_b16 v[32:33], v22 offset:16384
    ds_read_b64_tr_b16 v[34:35], v22 offset:16896
    v_mfma_f32_32x32x16_bf16 v[64:79], v[44:47], v[40:43], v[64:79]
    s_waitcnt lgkmcnt(0)
    v_mfma_f32_32x32x16_bf16 v[48:63], v[32:35], v[24:27], v[48:63]
    ds_read_b128 v[36:39], v17 offset:0
    ds_read_b128 v[40:43], v17 offset:4096
    ds_read_b64_tr_b16 v[44:45], v22 offset:18432
    ds_read_b64_tr_b16 v[46:47], v22 offset:18944
    v_mfma_f32_32x32x16_bf16 v[64:79], v[32:35], v[28:31], v[64:79]
    s_waitcnt lgkmcnt(0)
    v_mfma_f32_32x32x16_bf16 v[48:63], v[44:47], v[36:39], v[48:63]
    ds_read_b128 v[24:27], v18 offset:0
    ds_read_b128 v[28:31], v18 offset:4096
    ds_read_b64_tr_b16 v[32:33], v22 offset:20480
    ds_read_b64_tr_b16 v[34:35], v22 offset:20992
    v_mfma_f32_32x32x16_bf16 v[64:79], v[44:47], v[40:43], v[64:79]
    s_waitcnt lgkmcnt(0)
    v_mfma_f32_32x32x16_bf16 v[48:63], v[32:35], v[24:27], v[48:63]
    ds_read_b128 v[36:39], v19 offset:0
    ds_read_b128 v[40:43], v19 offset:4096
    ds_read_b64_tr_b16 v[44:45], v22 offset:22528
    ds_read_b64_tr_b16 v[46:47], v22 offset:23040
    v_mfma_f32_32x32x16_bf16 v[64:79], v[32:35], v[28:31], v[64:79]
    s_waitcnt lgkmcnt(0)
    s_barrier
    v_mfma_f32_32x32x16_bf16 v[48:63], v[44:47], v[36:39], v[48:63]
    ds_read_b128 v[24:27], v8 offset:0
    ds_read_b128 v[28:31], v8 offset:4096
    ds_read_b64_tr_b16 v[32:33], v20 offset:16384
    ds_read_b64_tr_b16 v[34:35], v20 offset:16896
    v_mfma_f32_32x32x16_bf16 v[64:79], v[44:47], v[40:43], v[64:79]
    s_waitcnt lgkmcnt(0)
    v_mfma_f32_32x32x16_bf16 v[48:63], v[32:35], v[24:27], v[48:63]
    ds_read_b128 v[36:39], v9 offset:0
    ds_read_b128 v[40:43], v9 offset:4096
    ds_read_b64_tr_b16 v[44:45], v20 offset:18432
    ds_read_b64_tr_b16 v[46:47], v20 offset:18944
    v_mfma_f32_32x32x16_bf16 v[64:79], v[32:35], v[28:31], v[64:79]
    s_waitcnt lgkmcnt(0)
    v_mfma_f32_32x32x16_bf16 v[48:63], v[44:47], v[36:39], v[48:63]
    ds_read_b128 v[24:27], v10 offset:0
    ds_read_b128 v[28:31], v10 offset:4096
    ds_read_b64_tr_b16 v[32:33], v20 offset:20480
    ds_read_b64_tr_b16 v[34:35], v20 offset:20992
    v_mfma_f32_32x32x16_bf16 v[64:79], v[44:47], v[40:43], v[64:79]
    s_waitcnt lgkmcnt(0)
    v_mfma_f32_32x32x16_bf16 v[48:63], v[32:35], v[24:27], v[48:63]
    ds_read_b128 v[36:39], v11 offset:0
    ds_read_b128 v[40:43], v11 offset:4096
    ds_read_b64_tr_b16 v[44:45], v20 offset:22528
    ds_read_b64_tr_b16 v[46:47], v20 offset:23040
    v_mfma_f32_32x32x16_bf16 v[64:79], v[32:35], v[28:31], v[64:79]
    s_waitcnt lgkmcnt(0)
    s_barrier
    v_mfma_f32_32x32x16_bf16 v[48:63], v[44:47], v[36:39], v[48:63]
    ds_read_b128 v[24:27], v12 offset:0
    ds_read_b128 v[28:31], v12 offset:4096
    ds_read_b64_tr_b16 v[32:33], v21 offset:16384
    ds_read_b64_tr_b16 v[34:35], v21 offset:16896
    v_mfma_f32_32x32x16_bf16 v[64:79], v[44:47], v[40:43], v[64:79]
    s_waitcnt lgkmcnt(0)
    v_mfma_f32_32x32x16_bf16 v[48:63], v[32:35], v[24:27], v[48:63]
    ds_read_b128 v[36:39], v13 offset:0
    ds_read_b128 v[40:43], v13 offset:4096
    ds_read_b64_tr_b16 v[44:45], v21 offset:18432
    ds_read_b64_tr_b16 v[46:47], v21 offset:18944
    s_waitcnt vmcnt(0)
    v_lshlrev_b32 v109, 16, v112
    v_and_b32 v110, 0xffff0000, v112
    v_lshlrev_b32 v111, 16, v128
    v_mul_f32 v109, v109, v111
    v_lshlrev_b32 v111, 16, v130
    v_mfma_f32_32x32x16_bf16 v[64:79], v[32:35], v[28:31], v[64:79]
    v_mul_f32 v110, v110, v111
    v_cvt_pk_bf16_f32 v144, v109, v110
    v_lshlrev_b32 v109, 16, v113
    v_and_b32 v110, 0xffff0000, v113
    v_lshlrev_b32 v111, 16, v132
    v_mul_f32 v109, v109, v111
    s_waitcnt lgkmcnt(0)
    v_mfma_f32_32x32x16_bf16 v[48:63], v[44:47], v[36:39], v[48:63]
    ds_read_b128 v[24:27], v14 offset:0
    ds_read_b128 v[28:31], v14 offset:4096
    ds_read_b64_tr_b16 v[32:33], v21 offset:20480
    ds_read_b64_tr_b16 v[34:35], v21 offset:20992
    v_lshlrev_b32 v111, 16, v134
    v_mul_f32 v110, v110, v111
    v_cvt_pk_bf16_f32 v145, v109, v110
    v_lshlrev_b32 v109, 16, v114
    v_and_b32 v110, 0xffff0000, v114
    v_lshlrev_b32 v111, 16, v136
    v_mfma_f32_32x32x16_bf16 v[64:79], v[44:47], v[40:43], v[64:79]
    v_mul_f32 v109, v109, v111
    v_lshlrev_b32 v111, 16, v138
    v_mul_f32 v110, v110, v111
    v_cvt_pk_bf16_f32 v146, v109, v110
    v_lshlrev_b32 v109, 16, v115
    v_and_b32 v110, 0xffff0000, v115
    s_waitcnt lgkmcnt(0)
    v_mfma_f32_32x32x16_bf16 v[48:63], v[32:35], v[24:27], v[48:63]
    ds_read_b128 v[36:39], v15 offset:0
    ds_read_b128 v[40:43], v15 offset:4096
    ds_read_b64_tr_b16 v[44:45], v21 offset:22528
    ds_read_b64_tr_b16 v[46:47], v21 offset:23040
    v_lshlrev_b32 v111, 16, v140
    v_mul_f32 v109, v109, v111
    v_lshlrev_b32 v111, 16, v142
    v_mul_f32 v110, v110, v111
    v_cvt_pk_bf16_f32 v147, v109, v110
    s_mov_b32 s78, 0
    v_mfma_f32_32x32x16_bf16 v[64:79], v[32:35], v[28:31], v[64:79]
    buffer_store_dwordx4 v[144:147], v108, s[64:67], s78 offen
    v_lshlrev_b32 v109, 16, v116
    v_and_b32 v110, 0xffff0000, v116
    v_and_b32 v111, 0xffff0000, v128
    v_mul_f32 v109, v109, v111
    v_and_b32 v111, 0xffff0000, v130
    s_waitcnt lgkmcnt(0)
    s_barrier
    v_mfma_f32_32x32x16_bf16 v[48:63], v[44:47], v[36:39], v[48:63]
    ds_read_b128 v[24:27], v16 offset:0
    ds_read_b128 v[28:31], v16 offset:4096
    ds_read_b64_tr_b16 v[32:33], v22 offset:16384
    ds_read_b64_tr_b16 v[34:35], v22 offset:16896
    v_mul_f32 v110, v110, v111
    v_cvt_pk_bf16_f32 v148, v109, v110
    v_lshlrev_b32 v109, 16, v117
    v_and_b32 v110, 0xffff0000, v117
    v_and_b32 v111, 0xffff0000, v132
    v_mul_f32 v109, v109, v111
    v_mfma_f32_32x32x16_bf16 v[64:79], v[44:47], v[40:43], v[64:79]
    v_and_b32 v111, 0xffff0000, v134
    v_mul_f32 v110, v110, v111
    v_cvt_pk_bf16_f32 v149, v109, v110
    v_lshlrev_b32 v109, 16, v118
    v_and_b32 v110, 0xffff0000, v118
    v_and_b32 v111, 0xffff0000, v136
    s_waitcnt lgkmcnt(0)
    v_mfma_f32_32x32x16_bf16 v[48:63], v[32:35], v[24:27], v[48:63]
    ds_read_b128 v[36:39], v17 offset:0
    ds_read_b128 v[40:43], v17 offset:4096
    ds_read_b64_tr_b16 v[44:45], v22 offset:18432
    ds_read_b64_tr_b16 v[46:47], v22 offset:18944
    v_mul_f32 v109, v109, v111
    v_and_b32 v111, 0xffff0000, v138
    v_mul_f32 v110, v110, v111
    v_cvt_pk_bf16_f32 v150, v109, v110
    v_lshlrev_b32 v109, 16, v119
    v_and_b32 v110, 0xffff0000, v119
    v_mfma_f32_32x32x16_bf16 v[64:79], v[32:35], v[28:31], v[64:79]
    v_and_b32 v111, 0xffff0000, v140
    v_mul_f32 v109, v109, v111
    v_and_b32 v111, 0xffff0000, v142
    v_mul_f32 v110, v110, v111
    v_cvt_pk_bf16_f32 v151, v109, v110
    s_mov_b32 s78, 4096
    s_waitcnt lgkmcnt(0)
    v_mfma_f32_32x32x16_bf16 v[48:63], v[44:47], v[36:39], v[48:63]
    ds_read_b128 v[24:27], v18 offset:0
    ds_read_b128 v[28:31], v18 offset:4096
    ds_read_b64_tr_b16 v[32:33], v22 offset:20480
    ds_read_b64_tr_b16 v[34:35], v22 offset:20992
    buffer_store_dwordx4 v[148:151], v108, s[64:67], s78 offen
    v_lshlrev_b32 v109, 16, v120
    v_and_b32 v110, 0xffff0000, v120
    v_lshlrev_b32 v111, 16, v129
    v_mul_f32 v109, v109, v111
    v_lshlrev_b32 v111, 16, v131
    v_mfma_f32_32x32x16_bf16 v[64:79], v[44:47], v[40:43], v[64:79]
    v_mul_f32 v110, v110, v111
    v_cvt_pk_bf16_f32 v144, v109, v110
    v_lshlrev_b32 v109, 16, v121
    v_and_b32 v110, 0xffff0000, v121
    v_lshlrev_b32 v111, 16, v133
    v_mul_f32 v109, v109, v111
    s_waitcnt lgkmcnt(0)
    v_mfma_f32_32x32x16_bf16 v[48:63], v[32:35], v[24:27], v[48:63]
    ds_read_b128 v[36:39], v19 offset:0
    ds_read_b128 v[40:43], v19 offset:4096
    ds_read_b64_tr_b16 v[44:45], v22 offset:22528
    ds_read_b64_tr_b16 v[46:47], v22 offset:23040
    v_lshlrev_b32 v111, 16, v135
    v_mul_f32 v110, v110, v111
    v_cvt_pk_bf16_f32 v145, v109, v110
    v_lshlrev_b32 v109, 16, v122
    v_and_b32 v110, 0xffff0000, v122
    v_lshlrev_b32 v111, 16, v137
    v_mfma_f32_32x32x16_bf16 v[64:79], v[32:35], v[28:31], v[64:79]
    v_mul_f32 v109, v109, v111
    v_lshlrev_b32 v111, 16, v139
    v_mul_f32 v110, v110, v111
    v_cvt_pk_bf16_f32 v146, v109, v110
    v_lshlrev_b32 v109, 16, v123
    v_and_b32 v110, 0xffff0000, v123
    s_waitcnt lgkmcnt(0)
    s_barrier
    v_mfma_f32_32x32x16_bf16 v[48:63], v[44:47], v[36:39], v[48:63]
    ds_read_b128 v[24:27], v8 offset:0
    ds_read_b128 v[28:31], v8 offset:4096
    ds_read_b64_tr_b16 v[32:33], v20 offset:16384
    ds_read_b64_tr_b16 v[34:35], v20 offset:16896
    v_lshlrev_b32 v111, 16, v141
    v_mul_f32 v109, v109, v111
    v_lshlrev_b32 v111, 16, v143
    v_mul_f32 v110, v110, v111
    v_cvt_pk_bf16_f32 v147, v109, v110
    s_mov_b32 s78, 8192
    v_mfma_f32_32x32x16_bf16 v[64:79], v[44:47], v[40:43], v[64:79]
    buffer_store_dwordx4 v[144:147], v108, s[64:67], s78 offen
    v_lshlrev_b32 v109, 16, v124
    v_and_b32 v110, 0xffff0000, v124
    v_and_b32 v111, 0xffff0000, v129
    v_mul_f32 v109, v109, v111
    v_and_b32 v111, 0xffff0000, v131
    s_waitcnt lgkmcnt(0)
    v_mfma_f32_32x32x16_bf16 v[48:63], v[32:35], v[24:27], v[48:63]
    ds_read_b128 v[36:39], v9 offset:0
    ds_read_b128 v[40:43], v9 offset:4096
    ds_read_b64_tr_b16 v[44:45], v20 offset:18432
    ds_read_b64_tr_b16 v[46:47], v20 offset:18944
    v_mul_f32 v110, v110, v111
    v_cvt_pk_bf16_f32 v148, v109, v110
    v_lshlrev_b32 v109, 16, v125
    v_and_b32 v110, 0xffff0000, v125
    v_and_b32 v111, 0xffff0000, v133
    v_mul_f32 v109, v109, v111
    v_mfma_f32_32x32x16_bf16 v[64:79], v[32:35], v[28:31], v[64:79]
    v_and_b32 v111, 0xffff0000, v135
    v_mul_f32 v110, v110, v111
    v_cvt_pk_bf16_f32 v149, v109, v110
    v_lshlrev_b32 v109, 16, v126
    v_and_b32 v110, 0xffff0000, v126
    v_and_b32 v111, 0xffff0000, v137
    s_waitcnt lgkmcnt(0)
    v_mfma_f32_32x32x16_bf16 v[48:63], v[44:47], v[36:39], v[48:63]
    ds_read_b128 v[24:27], v10 offset:0
    ds_read_b128 v[28:31], v10 offset:4096
    ds_read_b64_tr_b16 v[32:33], v20 offset:20480
    ds_read_b64_tr_b16 v[34:35], v20 offset:20992
    v_mul_f32 v109, v109, v111
    v_and_b32 v111, 0xffff0000, v139
    v_mul_f32 v110, v110, v111
    v_cvt_pk_bf16_f32 v150, v109, v110
    v_lshlrev_b32 v109, 16, v127
    v_and_b32 v110, 0xffff0000, v127
    v_mfma_f32_32x32x16_bf16 v[64:79], v[44:47], v[40:43], v[64:79]
    v_and_b32 v111, 0xffff0000, v141
    v_mul_f32 v109, v109, v111
    v_and_b32 v111, 0xffff0000, v143
    v_mul_f32 v110, v110, v111
    v_cvt_pk_bf16_f32 v151, v109, v110
    s_mov_b32 s78, 12288
    s_waitcnt lgkmcnt(0)
    v_mfma_f32_32x32x16_bf16 v[48:63], v[32:35], v[24:27], v[48:63]
    ds_read_b128 v[36:39], v11 offset:0
    ds_read_b128 v[40:43], v11 offset:4096
    ds_read_b64_tr_b16 v[44:45], v20 offset:22528
    ds_read_b64_tr_b16 v[46:47], v20 offset:23040
    buffer_store_dwordx4 v[148:151], v108, s[64:67], s78 offen
    v_mfma_f32_32x32x16_bf16 v[64:79], v[32:35], v[28:31], v[64:79]
    s_waitcnt lgkmcnt(0)
    v_mfma_f32_32x32x16_bf16 v[48:63], v[44:47], v[36:39], v[48:63]
    v_mfma_f32_32x32x16_bf16 v[64:79], v[44:47], v[40:43], v[64:79]
    s_bfe_u32 s26, s3, 0x10001
    s_lshl_b32 s26, s26, 18
    s_lshl_b32 s24, s6, 19
    s_add_u32 s26, s26, s24
    s_add_u32 s26, s26, s25
    s_and_b32 s24, s3, 1
    s_lshl_b32 s24, s24, 6
    s_add_u32 s26, s26, s24
    s_add_u32 s26, s26, 2048
    v_and_b32 v2, 31, v0
    v_lshlrev_b32 v2, 12, v2
    v_lshrrev_b32 v3, 5, v0
    v_lshl_add_u32 v2, v3, 4, v2
    v_add_u32 v2, s26, v2
    v_add_u32 v3, 0x20000, v2
    s_nop 7
    s_nop 4
    v_cvt_pk_bf16_f32 v80, v48, v49
    v_cvt_pk_bf16_f32 v81, v50, v51
    v_cvt_pk_bf16_f32 v82, v52, v53
    v_cvt_pk_bf16_f32 v83, v54, v55
    v_cvt_pk_bf16_f32 v84, v56, v57
    v_cvt_pk_bf16_f32 v85, v58, v59
    v_cvt_pk_bf16_f32 v86, v60, v61
    v_cvt_pk_bf16_f32 v87, v62, v63
    s_nop 1
    v_permlane32_swap_b32 v80, v82
    v_permlane32_swap_b32 v81, v83
    v_permlane32_swap_b32 v84, v86
    v_permlane32_swap_b32 v85, v87
    buffer_store_dwordx4 v[80:83], v2, s[20:23], 0 offen offset:0
    buffer_store_dwordx4 v[84:87], v2, s[20:23], 0 offen offset:32
    v_cvt_pk_bf16_f32 v88, v64, v65
    v_cvt_pk_bf16_f32 v89, v66, v67
    v_cvt_pk_bf16_f32 v90, v68, v69
    v_cvt_pk_bf16_f32 v91, v70, v71
    v_cvt_pk_bf16_f32 v92, v72, v73
    v_cvt_pk_bf16_f32 v93, v74, v75
    v_cvt_pk_bf16_f32 v94, v76, v77
    v_cvt_pk_bf16_f32 v95, v78, v79
    s_nop 1
    v_permlane32_swap_b32 v88, v90
    v_permlane32_swap_b32 v89, v91
    v_permlane32_swap_b32 v92, v94
    v_permlane32_swap_b32 v93, v95
    buffer_store_dwordx4 v[88:91], v3, s[20:23], 0 offen offset:0
    buffer_store_dwordx4 v[92:95], v3, s[20:23], 0 offen offset:32
    s_branch Ldone
Lp3_loader:
    s_cmp_lg_u32 s3, 4
    s_cbranch_scc1 Lnso
    s_lshl_b32 s5, s6, 8
    s_add_u32 s5, s5, 4096
    v_mov_b32 v100, s5
    v_mov_b32 v101, 1
    s_mov_b64 exec, 1
    buffer_atomic_add v101, v100, s[8:11], 0 offen sc1
    s_mov_b64 exec, -1
Lnso:
    s_load_dwordx4 s[28:31], s[0:1], 72
    s_load_dwordx2 s[32:33], s[0:1], 96
    s_lshl_b32 s24, s6, 18
    s_lshl_b32 s25, s7, 7
    s_waitcnt lgkmcnt(0)
    s_add_u32 s12, s32, 12582912
    s_addc_u32 s13, s33, 0
    s_mov_b32 s14, 4194304
    s_mov_b32 s15, 0x00020000
    s_mov_b32 s16, s28
    s_mov_b32 s17, s29
    s_mov_b32 s18, 2097152
    s_mov_b32 s19, 0x00020000
    s_mov_b32 s20, s30
    s_mov_b32 s21, s31
    s_mov_b32 s22, 8388608
    s_mov_b32 s23, 0x00020000
    v_lshrrev_b32 v5, 3, v0
    v_and_b32 v6, 7, v0
    v_lshrrev_b32 v7, 4, v0
    v_xor_b32 v2, v6, v7
    v_xor_b32 v3, 4, v2
    v_lshlrev_b32 v2, 4, v2
    v_lshl_add_u32 v2, v5, 11, v2
    v_lshlrev_b32 v3, 4, v3
    v_lshl_add_u32 v3, v5, 11, v3
    v_and_b32 v7, 2, v5
    v_lshlrev_b32 v7, 1, v7
    v_xor_b32 v4, v6, v7
    v_lshlrev_b32 v4, 4, v4
    s_mov_b32 s36, 2048
    v_mul_lo_u32 v7, v5, s36
    v_add_u32 v4, v4, v7
    s_and_b32 s39, s3, 3
    s_mul_i32 s36, s39, 65536
    s_add_u32 s38, s24, s36
    s_mul_i32 s42, s39, 4096
    s_mul_i32 s43, s39, 2048
    s_mul_i32 s36, s39, 2
    s_add_u32 s36, s36, 0
    s_lshr_b32 s37, s36, 3
    s_and_b32 s36, s36, 7
    s_lshl_b32 s37, s37, 11
    s_mul_i32 s36, s36, 16384
    s_add_u32 s40, s36, s37
    s_add_u32 s40, s40, s25
    s_mul_i32 s36, s39, 2
    s_add_u32 s36, s36, 1
    s_lshr_b32 s37, s36, 3
    s_and_b32 s36, s36, 7
    s_lshl_b32 s37, s37, 11
    s_mul_i32 s36, s36, 16384
    s_add_u32 s41, s36, s37
    s_add_u32 s41, s41, s25
    s_add_u32 m0, s43, 101376
    s_add_u32 s37, s40, 0
    buffer_load_dwordx4 v4, s[16:19], s37 offen lds
    s_add_u32 m0, s43, 102400
    s_add_u32 s37, s41, 0
    buffer_load_dwordx4 v4, s[16:19], s37 offen lds
    s_add_u32 m0, s43, 125952
    s_add_u32 s37, s40, 131072
    buffer_load_dwordx4 v4, s[16:19], s37 offen lds
    s_add_u32 m0, s43, 126976
    s_add_u32 s37, s41, 131072
    buffer_load_dwordx4 v4, s[16:19], s37 offen lds
    s_and_b32 s5, s6, 7
    s_lshl_b32 s5, s5, 2
    s_and_b32 s34, s3, 3
    s_add_u32 s5, s5, s34
    s_lshl_b32 s5, s5, 5
    v_and_b32 v100, 31, v0
    v_add_u32 v100, s5, v100
    v_lshlrev_b32 v100, 11, v100
    buffer_load_dword v103, v100, s[16:19], s25 offen
    s_cmp_lg_u32 s3, 4
    s_cbranch_scc1 Lxw
    s_lshl_b32 s5, s6, 8
    s_add_u32 s5, s5, 4096
    v_mov_b32 v100, s5
    s_mov_b32 s99, 0
    Lpoll_o:
    buffer_load_dword v101, v100, s[8:11], 0 offen sc1
    s_waitcnt vmcnt(0)
    v_readfirstlane_b32 s5, v101
    s_nop 3
    s_cmp_ge_u32 s5, 16
    s_cbranch_scc1 Lpoll_o_done
    s_sleep 2
    s_add_u32 s99, s99, 1
    s_cmp_lt_u32 s99, 0x40000
    s_cbranch_scc1 Lpoll_o
    Lpoll_o_done:
    v_mov_b32 v100, 163796
    v_mov_b32 v101, 1
    s_mov_b64 exec, 1
    ds_add_u32 v100, v101
    s_mov_b64 exec, -1
Lxw:
    v_mov_b32 v100, 163796
    s_mov_b32 s99, 0
    Lw7:
    ds_read_b32 v101, v100
    s_waitcnt lgkmcnt(0)
    v_readfirstlane_b32 s5, v101
    s_add_u32 s99, s99, 1
    s_cmp_ge_u32 s99, 0x400000
    s_cbranch_scc1 Lw7_done
    s_cmp_lt_u32 s5, 1
    s_cbranch_scc1 Lw7
    Lw7_done:
    s_waitcnt vmcnt(0)
    s_add_u32 m0, s42, 84992
    s_add_u32 s37, s38, 0
    buffer_load_dwordx4 v2, s[12:15], s37 offen sc1 lds
    s_add_u32 m0, s42, 86016
    s_add_u32 s37, s38, 16384
    buffer_load_dwordx4 v3, s[12:15], s37 offen sc1 lds
    s_add_u32 m0, s42, 87040
    s_add_u32 s37, s38, 32768
    buffer_load_dwordx4 v2, s[12:15], s37 offen sc1 lds
    s_add_u32 m0, s42, 88064
    s_add_u32 s37, s38, 49152
    buffer_load_dwordx4 v3, s[12:15], s37 offen sc1 lds
    s_add_u32 m0, s42, 109568
    s_add_u32 s37, s38, 128
    buffer_load_dwordx4 v2, s[12:15], s37 offen sc1 lds
    s_add_u32 m0, s42, 110592
    s_add_u32 s37, s38, 16512
    buffer_load_dwordx4 v3, s[12:15], s37 offen sc1 lds
    s_add_u32 m0, s42, 111616
    s_add_u32 s37, s38, 32896
    buffer_load_dwordx4 v2, s[12:15], s37 offen sc1 lds
    s_add_u32 m0, s42, 112640
    s_add_u32 s37, s38, 49280
    buffer_load_dwordx4 v3, s[12:15], s37 offen sc1 lds
    s_and_b32 s5, s7, 3
    s_lshl_b32 s5, s5, 2
    s_and_b32 s34, s3, 3
    s_add_u32 s5, s5, s34
    s_lshl_b32 s5, s5, 3
    v_lshrrev_b32 v100, 3, v0
    v_add_u32 v100, s5, v100
    v_lshlrev_b32 v100, 11, v100
    v_and_b32 v101, 7, v0
    v_lshl_add_u32 v100, v101, 7, v100
    buffer_load_dword v103, v100, s[12:15], s24 offen sc1
    buffer_load_dword v103, v100, s[12:15], s24 offen offset:1024 sc1
    s_waitcnt vmcnt(6)
    s_barrier
    s_add_u32 m0, s42, 134144
    s_add_u32 s37, s38, 256
    buffer_load_dwordx4 v2, s[12:15], s37 offen sc1 lds
    s_add_u32 m0, s42, 135168
    s_add_u32 s37, s38, 16640
    buffer_load_dwordx4 v3, s[12:15], s37 offen sc1 lds
    s_add_u32 m0, s42, 136192
    s_add_u32 s37, s38, 33024
    buffer_load_dwordx4 v2, s[12:15], s37 offen sc1 lds
    s_add_u32 m0, s42, 137216
    s_add_u32 s37, s38, 49408
    buffer_load_dwordx4 v3, s[12:15], s37 offen sc1 lds
    s_add_u32 m0, s43, 150528
    s_add_u32 s37, s40, 262144
    buffer_load_dwordx4 v4, s[16:19], s37 offen lds
    s_add_u32 m0, s43, 151552
    s_add_u32 s37, s41, 262144
    buffer_load_dwordx4 v4, s[16:19], s37 offen lds
    s_waitcnt vmcnt(8)
    s_barrier
    s_add_u32 m0, s42, 84992
    s_add_u32 s37, s38, 384
    buffer_load_dwordx4 v2, s[12:15], s37 offen sc1 lds
    s_add_u32 m0, s42, 86016
    s_add_u32 s37, s38, 16768
    buffer_load_dwordx4 v3, s[12:15], s37 offen sc1 lds
    s_add_u32 m0, s42, 87040
    s_add_u32 s37, s38, 33152
    buffer_load_dwordx4 v2, s[12:15], s37 offen sc1 lds
    s_add_u32 m0, s42, 88064
    s_add_u32 s37, s38, 49536
    buffer_load_dwordx4 v3, s[12:15], s37 offen sc1 lds
    s_add_u32 m0, s43, 101376
    s_add_u32 s37, s40, 393216
    buffer_load_dwordx4 v4, s[16:19], s37 offen lds
    s_add_u32 m0, s43, 102400
    s_add_u32 s37, s41, 393216
    buffer_load_dwordx4 v4, s[16:19], s37 offen lds
    s_waitcnt vmcnt(6)
    s_barrier
    s_add_u32 m0, s42, 109568
    s_add_u32 s37, s38, 512
    buffer_load_dwordx4 v2, s[12:15], s37 offen sc1 lds
    s_add_u32 m0, s42, 110592
    s_add_u32 s37, s38, 16896
    buffer_load_dwordx4 v3, s[12:15], s37 offen sc1 lds
    s_add_u32 m0, s42, 111616
    s_add_u32 s37, s38, 33280
    buffer_load_dwordx4 v2, s[12:15], s37 offen sc1 lds
    s_add_u32 m0, s42, 112640
    s_add_u32 s37, s38, 49664
    buffer_load_dwordx4 v3, s[12:15], s37 offen sc1 lds
    s_add_u32 m0, s43, 125952
    s_add_u32 s37, s40, 524288
    buffer_load_dwordx4 v4, s[16:19], s37 offen lds
    s_add_u32 m0, s43, 126976
    s_add_u32 s37, s41, 524288
    buffer_load_dwordx4 v4, s[16:19], s37 offen lds
    s_waitcnt vmcnt(6)
    s_barrier
    s_add_u32 m0, s42, 134144
    s_add_u32 s37, s38, 640
    buffer_load_dwordx4 v2, s[12:15], s37 offen sc1 lds
    s_add_u32 m0, s42, 135168
    s_add_u32 s37, s38, 17024
    buffer_load_dwordx4 v3, s[12:15], s37 offen sc1 lds
    s_add_u32 m0, s42, 136192
    s_add_u32 s37, s38, 33408
    buffer_load_dwordx4 v2, s[12:15], s37 offen sc1 lds
    s_add_u32 m0, s42, 137216
    s_add_u32 s37, s38, 49792
    buffer_load_dwordx4 v3, s[12:15], s37 offen sc1 lds
    s_add_u32 m0, s43, 150528
    s_add_u32 s37, s40, 655360
    buffer_load_dwordx4 v4, s[16:19], s37 offen lds
    s_add_u32 m0, s43, 151552
    s_add_u32 s37, s41, 655360
    buffer_load_dwordx4 v4, s[16:19], s37 offen lds
    s_waitcnt vmcnt(6)
    s_barrier
    s_add_u32 m0, s42, 84992
    s_add_u32 s37, s38, 768
    buffer_load_dwordx4 v2, s[12:15], s37 offen sc1 lds
    s_add_u32 m0, s42, 86016
    s_add_u32 s37, s38, 17152
    buffer_load_dwordx4 v3, s[12:15], s37 offen sc1 lds
    s_add_u32 m0, s42, 87040
    s_add_u32 s37, s38, 33536
    buffer_load_dwordx4 v2, s[12:15], s37 offen sc1 lds
    s_add_u32 m0, s42, 88064
    s_add_u32 s37, s38, 49920
    buffer_load_dwordx4 v3, s[12:15], s37 offen sc1 lds
    s_add_u32 m0, s43, 101376
    s_add_u32 s37, s40, 786432
    buffer_load_dwordx4 v4, s[16:19], s37 offen lds
    s_add_u32 m0, s43, 102400
    s_add_u32 s37, s41, 786432
    buffer_load_dwordx4 v4, s[16:19], s37 offen lds
    s_waitcnt vmcnt(6)
    s_barrier
    s_add_u32 m0, s42, 109568
    s_add_u32 s37, s38, 896
    buffer_load_dwordx4 v2, s[12:15], s37 offen sc1 lds
    s_add_u32 m0, s42, 110592
    s_add_u32 s37, s38, 17280
    buffer_load_dwordx4 v3, s[12:15], s37 offen sc1 lds
    s_add_u32 m0, s42, 111616
    s_add_u32 s37, s38, 33664
    buffer_load_dwordx4 v2, s[12:15], s37 offen sc1 lds
    s_add_u32 m0, s42, 112640
    s_add_u32 s37, s38, 50048
    buffer_load_dwordx4 v3, s[12:15], s37 offen sc1 lds
    s_add_u32 m0, s43, 125952
    s_add_u32 s37, s40, 917504
    buffer_load_dwordx4 v4, s[16:19], s37 offen lds
    s_add_u32 m0, s43, 126976
    s_add_u32 s37, s41, 917504
    buffer_load_dwordx4 v4, s[16:19], s37 offen lds
    s_waitcnt vmcnt(6)
    s_barrier
    s_add_u32 m0, s42, 134144
    s_add_u32 s37, s38, 1024
    buffer_load_dwordx4 v2, s[12:15], s37 offen sc1 lds
    s_add_u32 m0, s42, 135168
    s_add_u32 s37, s38, 17408
    buffer_load_dwordx4 v3, s[12:15], s37 offen sc1 lds
    s_add_u32 m0, s42, 136192
    s_add_u32 s37, s38, 33792
    buffer_load_dwordx4 v2, s[12:15], s37 offen sc1 lds
    s_add_u32 m0, s42, 137216
    s_add_u32 s37, s38, 50176
    buffer_load_dwordx4 v3, s[12:15], s37 offen sc1 lds
    s_add_u32 m0, s43, 150528
    s_add_u32 s37, s40, 1048576
    buffer_load_dwordx4 v4, s[16:19], s37 offen lds
    s_add_u32 m0, s43, 151552
    s_add_u32 s37, s41, 1048576
    buffer_load_dwordx4 v4, s[16:19], s37 offen lds
    s_waitcnt vmcnt(6)
    s_barrier
    s_add_u32 m0, s42, 84992
    s_add_u32 s37, s38, 1152
    buffer_load_dwordx4 v2, s[12:15], s37 offen sc1 lds
    s_add_u32 m0, s42, 86016
    s_add_u32 s37, s38, 17536
    buffer_load_dwordx4 v3, s[12:15], s37 offen sc1 lds
    s_add_u32 m0, s42, 87040
    s_add_u32 s37, s38, 33920
    buffer_load_dwordx4 v2, s[12:15], s37 offen sc1 lds
    s_add_u32 m0, s42, 88064
    s_add_u32 s37, s38, 50304
    buffer_load_dwordx4 v3, s[12:15], s37 offen sc1 lds
    s_add_u32 m0, s43, 101376
    s_add_u32 s37, s40, 1179648
    buffer_load_dwordx4 v4, s[16:19], s37 offen lds
    s_add_u32 m0, s43, 102400
    s_add_u32 s37, s41, 1179648
    buffer_load_dwordx4 v4, s[16:19], s37 offen lds
    s_waitcnt vmcnt(6)
    s_barrier
    s_add_u32 m0, s42, 109568
    s_add_u32 s37, s38, 1280
    buffer_load_dwordx4 v2, s[12:15], s37 offen sc1 lds
    s_add_u32 m0, s42, 110592
    s_add_u32 s37, s38, 17664
    buffer_load_dwordx4 v3, s[12:15], s37 offen sc1 lds
    s_add_u32 m0, s42, 111616
    s_add_u32 s37, s38, 34048
    buffer_load_dwordx4 v2, s[12:15], s37 offen sc1 lds
    s_add_u32 m0, s42, 112640
    s_add_u32 s37, s38, 50432
    buffer_load_dwordx4 v3, s[12:15], s37 offen sc1 lds
    s_add_u32 m0, s43, 125952
    s_add_u32 s37, s40, 1310720
    buffer_load_dwordx4 v4, s[16:19], s37 offen lds
    s_add_u32 m0, s43, 126976
    s_add_u32 s37, s41, 1310720
    buffer_load_dwordx4 v4, s[16:19], s37 offen lds
    s_waitcnt vmcnt(6)
    s_barrier
    s_add_u32 m0, s42, 134144
    s_add_u32 s37, s38, 1408
    buffer_load_dwordx4 v2, s[12:15], s37 offen sc1 lds
    s_add_u32 m0, s42, 135168
    s_add_u32 s37, s38, 17792
    buffer_load_dwordx4 v3, s[12:15], s37 offen sc1 lds
    s_add_u32 m0, s42, 136192
    s_add_u32 s37, s38, 34176
    buffer_load_dwordx4 v2, s[12:15], s37 offen sc1 lds
    s_add_u32 m0, s42, 137216
    s_add_u32 s37, s38, 50560
    buffer_load_dwordx4 v3, s[12:15], s37 offen sc1 lds
    s_add_u32 m0, s43, 150528
    s_add_u32 s37, s40, 1441792
    buffer_load_dwordx4 v4, s[16:19], s37 offen lds
    s_add_u32 m0, s43, 151552
    s_add_u32 s37, s41, 1441792
    buffer_load_dwordx4 v4, s[16:19], s37 offen lds
    s_waitcnt vmcnt(6)
    s_barrier
    s_add_u32 m0, s42, 84992
    s_add_u32 s37, s38, 1536
    buffer_load_dwordx4 v2, s[12:15], s37 offen sc1 lds
    s_add_u32 m0, s42, 86016
    s_add_u32 s37, s38, 17920
    buffer_load_dwordx4 v3, s[12:15], s37 offen sc1 lds
    s_add_u32 m0, s42, 87040
    s_add_u32 s37, s38, 34304
    buffer_load_dwordx4 v2, s[12:15], s37 offen sc1 lds
    s_add_u32 m0, s42, 88064
    s_add_u32 s37, s38, 50688
    buffer_load_dwordx4 v3, s[12:15], s37 offen sc1 lds
    s_add_u32 m0, s43, 101376
    s_add_u32 s37, s40, 1572864
    buffer_load_dwordx4 v4, s[16:19], s37 offen lds
    s_add_u32 m0, s43, 102400
    s_add_u32 s37, s41, 1572864
    buffer_load_dwordx4 v4, s[16:19], s37 offen lds
    s_waitcnt vmcnt(6)
    s_barrier
    s_add_u32 m0, s42, 109568
    s_add_u32 s37, s38, 1664
    buffer_load_dwordx4 v2, s[12:15], s37 offen sc1 lds
    s_add_u32 m0, s42, 110592
    s_add_u32 s37, s38, 18048
    buffer_load_dwordx4 v3, s[12:15], s37 offen sc1 lds
    s_add_u32 m0, s42, 111616
    s_add_u32 s37, s38, 34432
    buffer_load_dwordx4 v2, s[12:15], s37 offen sc1 lds
    s_add_u32 m0, s42, 112640
    s_add_u32 s37, s38, 50816
    buffer_load_dwordx4 v3, s[12:15], s37 offen sc1 lds
    s_add_u32 m0, s43, 125952
    s_add_u32 s37, s40, 1703936
    buffer_load_dwordx4 v4, s[16:19], s37 offen lds
    s_add_u32 m0, s43, 126976
    s_add_u32 s37, s41, 1703936
    buffer_load_dwordx4 v4, s[16:19], s37 offen lds
    s_waitcnt vmcnt(6)
    s_barrier
    s_add_u32 m0, s42, 134144
    s_add_u32 s37, s38, 1792
    buffer_load_dwordx4 v2, s[12:15], s37 offen sc1 lds
    s_add_u32 m0, s42, 135168
    s_add_u32 s37, s38, 18176
    buffer_load_dwordx4 v3, s[12:15], s37 offen sc1 lds
    s_add_u32 m0, s42, 136192
    s_add_u32 s37, s38, 34560
    buffer_load_dwordx4 v2, s[12:15], s37 offen sc1 lds
    s_add_u32 m0, s42, 137216
    s_add_u32 s37, s38, 50944
    buffer_load_dwordx4 v3, s[12:15], s37 offen sc1 lds
    s_add_u32 m0, s43, 150528
    s_add_u32 s37, s40, 1835008
    buffer_load_dwordx4 v4, s[16:19], s37 offen lds
    s_add_u32 m0, s43, 151552
    s_add_u32 s37, s41, 1835008
    buffer_load_dwordx4 v4, s[16:19], s37 offen lds
    s_waitcnt vmcnt(6)
    s_barrier
    s_add_u32 m0, s42, 84992
    s_add_u32 s37, s38, 1920
    buffer_load_dwordx4 v2, s[12:15], s37 offen sc1 lds
    s_add_u32 m0, s42, 86016
    s_add_u32 s37, s38, 18304
    buffer_load_dwordx4 v3, s[12:15], s37 offen sc1 lds
    s_add_u32 m0, s42, 87040
    s_add_u32 s37, s38, 34688
    buffer_load_dwordx4 v2, s[12:15], s37 offen sc1 lds
    s_add_u32 m0, s42, 88064
    s_add_u32 s37, s38, 51072
    buffer_load_dwordx4 v3, s[12:15], s37 offen sc1 lds
    s_add_u32 m0, s43, 101376
    s_add_u32 s37, s40, 1966080
    buffer_load_dwordx4 v4, s[16:19], s37 offen lds
    s_add_u32 m0, s43, 102400
    s_add_u32 s37, s41, 1966080
    buffer_load_dwordx4 v4, s[16:19], s37 offen lds
    s_waitcnt vmcnt(6)
    s_barrier
    s_waitcnt vmcnt(0)
    s_barrier
Ldone:
Lexit:
    s_endpgm
Lcodeend:
.section .rodata,"a"
.p2align 6
.amdhsa_kernel concat_heads__ssm_conv_h3__linear_kernel_hedgehog__prompt_kernel
  .amdhsa_next_free_vgpr 256
  .amdhsa_next_free_sgpr 102
  .amdhsa_accum_offset 256
  .amdhsa_group_segment_fixed_size 0
  .amdhsa_kernarg_size 104
  .amdhsa_user_sgpr_count 2
  .amdhsa_user_sgpr_kernarg_segment_ptr 1
  .amdhsa_system_sgpr_workgroup_id_x 1
.end_amdhsa_kernel
```
